```python
import torch

def _softmax(x, axis=-1):
    return torch.softmax(x, dim=axis)
def _gelu(x):
    return torch.nn.functional.gelu(x, approximate="tanh")
def _silu(x):
    return torch.nn.functional.silu(x)
def _sigmoid(x):
    return torch.sigmoid(x)
def _layernorm(x, axis=-1, eps=1e-5):
    m = x.mean(dim=axis, keepdim=True)
    v = x.var(dim=axis, keepdim=True, unbiased=False)
    return (x - m) / torch.sqrt(v + eps)
def _scatter_add(tgt, idx, src, axis=0):
    return tgt.clone().index_add_(axis, idx, src)
def _segment_sum(src, seg, n):
    out = torch.zeros((n,) + src.shape[1:], dtype=src.dtype)
    return out.index_add_(0, seg, src)
def _pad(x, pw):
    flat = tuple(v for pair in reversed(pw) for v in pair)
    return torch.nn.functional.pad(x, flat)

kernel_name = 'interleave_layers__gqa_block_cached__mixer_token_mlp__decode'

def setup_inputs():

    _w = (lambda a: (lambda t: t.to(torch.bfloat16) if t.is_floating_point() else t)(torch.as_tensor(a)))
    def _A_setup():
        B, Sq, D = 2, 1, 576
        Hq, Hkv, Sk, Dh = 32, 16, 16384, 128
        assert Hq % Hkv == 0, (Hq, Hkv)
        return {
            "x": _w((lambda *s: torch.randn(*s, dtype=torch.bfloat16) * 0.1)(B, Sq, D)),
            "k_cache": _w((lambda *s: torch.randn(*s, dtype=torch.bfloat16) * 0.8)(B, Hkv, Sk, Dh)),
            "v_cache": _w((lambda *s: torch.randn(*s, dtype=torch.bfloat16) * 3.2)(B, Hkv, Sk, Dh)),
            "wq": _w((lambda *s: torch.randn(*s, dtype=torch.bfloat16) * 0.8)(D, Hq * Dh) * (D ** -0.5)),
            "wo": _w((lambda *s: torch.randn(*s, dtype=torch.bfloat16) * 3.2)(Hq * Dh, D) * ((Hq * Dh) ** -0.5)),
        }
    _A_in = _A_setup()

    def _B_setup():
        B, S, D, F = 2, 1, 576, 4608
        return {
            "x": _w((lambda *s: torch.randn(*s, dtype=torch.bfloat16) * 0.1)(B, S, D)),
            "w1": _w((lambda *s: torch.randn(*s, dtype=torch.bfloat16) * 0.8)(S, F) * (S ** -0.5)),
            "b1": _w((lambda *s: torch.randn(*s, dtype=torch.bfloat16) * 0.8)(F) * 0.02),
            "w2": _w((lambda *s: torch.randn(*s, dtype=torch.bfloat16) * 0.4)(F, S) * (F ** -0.5)),
            "b2": _w((lambda *s: torch.randn(*s, dtype=torch.bfloat16) * 0.4)(S) * 0.02),
        }
    _B_in = _B_setup()

    return {
        "A_x": _A_in["x"],
        "A_k_cache": _A_in["k_cache"],
        "A_v_cache": _A_in["v_cache"],
        "A_wq": _A_in["wq"],
        "A_wo": _A_in["wo"],
        "B_x": _B_in["x"],
        "B_w1": _B_in["w1"],
        "B_b1": _B_in["b1"],
        "B_w2": _B_in["w2"],
        "B_b2": _B_in["b2"],
    }

def reference(A_x, A_k_cache, A_v_cache, A_wq, A_wo, B_x, B_w1, B_b1, B_w2, B_b2):
    def _A_ref(x, k_cache, v_cache, wq, wo):
        B, Sq, D = x.shape
        Hq, Dh = 32, 128
        Hkv = k_cache.shape[1]
        rep = Hq // Hkv
        q = (lambda x, *d: x.permute(*d))((x @ wq).reshape(B, Sq, Hq, Dh), 0, 2, 1, 3)
        k = (lambda x, n, axis: torch.repeat_interleave(x, n, dim=axis))(k_cache, rep, axis=1)
        v = (lambda x, n, axis: torch.repeat_interleave(x, n, dim=axis))(v_cache, rep, axis=1)
        scores = torch.einsum("bhqd,bhkd->bhqk", q, k) * (Dh ** -0.5)
        p = _softmax(scores, axis=-1)
        o = torch.einsum("bhqk,bhkd->bhqd", p, v)
        return (lambda x, *d: x.permute(*d))(o, 0, 2, 1, 3).reshape(B, Sq, Hq * Dh) @ wo

    def _B_ref(x, w1, b1, w2, b2):
        B, S, D = x.shape
        h = _layernorm(x, axis=-1)
        u = torch.einsum("bsd,sf->bdf", h, w1) + b1
        u = _gelu(u)
        y = torch.einsum("bdf,fs->bds", u, w2) + b2
        return (lambda x, *d: x.permute(*d))(y, 0, 2, 1)

    x = A_x
    x = x + _A_ref(_layernorm(x, axis=-1), A_k_cache, A_v_cache, A_wq, A_wo)
    x = x + _B_ref(_layernorm(x, axis=-1), B_w1, B_b1, B_w2, B_b2)
    x = x + _A_ref(_layernorm(x, axis=-1), A_k_cache, A_v_cache, A_wq, A_wo)
    x = x + _B_ref(_layernorm(x, axis=-1), B_w1, B_b1, B_w2, B_b2)
    return x
```

```asm
; @launch grid=(256,1,1) block=(256,1,1) lds=163840
.amdgcn_target "amdgcn-amd-amdhsa--gfx950"
.text
.globl interleave_layers__gqa_block_cached__mixer_token_mlp__decode_kernel
.p2align 8
.type interleave_layers__gqa_block_cached__mixer_token_mlp__decode_kernel,@function
interleave_layers__gqa_block_cached__mixer_token_mlp__decode_kernel:
    s_cmp_ge_u32 s2, 256
    s_cbranch_scc1 L_end
    s_load_dwordx16 s[32:47], s[0:1], 0
    s_load_dwordx8 s[48:55], s[0:1], 64
    s_load_dwordx2 s[56:57], s[0:1], 96
    v_lshrrev_b32 v1, 6, v0
    s_nop 0
    v_readfirstlane_b32 s3, v1
    v_and_b32 v0, 63, v0
    s_mov_b32 s69, s2
    s_and_b32 s4, s2, 7
    s_lshl_b32 s4, s4, 1
    s_bfe_u32 s6, s2, 0x10003
    s_or_b32 s4, s4, s6
    s_lshr_b32 s6, s2, 4
    s_lshl_b32 s2, s4, 4
    s_or_b32 s2, s2, s6
    s_add_u32 s5, s6, s4
    s_and_b32 s5, s5, 15
    v_lshlrev_b32 v2, 4, v0
    v_bfe_u32 v1, v0, 2, 2
    v_lshlrev_b32 v1, 11, v1
    v_bfe_u32 v3, v0, 1, 1
    v_lshl_add_u32 v1, v3, 8, v1
    v_lshrrev_b32 v3, 4, v0
    v_lshl_add_u32 v1, v3, 5, v1
    v_and_b32 v3, 1, v0
    v_lshl_add_u32 v1, v3, 4, v1
    s_lshl_b32 s27, s2, 18
    s_lshl_b32 s28, s3, 16
    s_add_u32 s27, s27, s28
    s_mov_b32 s10, 0x8000000
    s_mov_b32 s11, 0x20000
    s_mov_b32 s14, 0x8000000
    s_mov_b32 s15, 0x20000
    s_mov_b32 s18, 0x20000000
    s_mov_b32 s19, 0x20000
    s_mov_b32 s23, 0x20000
    s_waitcnt lgkmcnt(0)
    s_mov_b32 s8, s34
    s_mov_b32 s9, s35
    s_add_u32 s28, s27, 0
    buffer_load_dwordx4 a[0:3], v1, s[8:11], s28 offen offset:0 nt
    buffer_load_dwordx4 a[4:7], v1, s[8:11], s28 offen offset:128 nt
    buffer_load_dwordx4 a[8:11], v1, s[8:11], s28 offen offset:512 nt
    buffer_load_dwordx4 a[12:15], v1, s[8:11], s28 offen offset:640 nt
    buffer_load_dwordx4 a[16:19], v1, s[8:11], s28 offen offset:1024 nt
    buffer_load_dwordx4 a[20:23], v1, s[8:11], s28 offen offset:1152 nt
    buffer_load_dwordx4 a[24:27], v1, s[8:11], s28 offen offset:1536 nt
    buffer_load_dwordx4 a[28:31], v1, s[8:11], s28 offen offset:1664 nt
    s_mov_b32 s12, s36
    s_mov_b32 s13, s37
    s_mov_b32 s16, s56
    s_mov_b32 s17, s57
    s_mov_b32 s82, 1
    s_mov_b32 s79, 0
    s_cmp_ge_u32 s5, 9
    s_cselect_b32 s42, 1, 0
    s_mov_b32 s24, 0xaaaaaaaa
    s_mov_b32 s25, 0xaaaaaaaa
    v_and_b32 v4, 4, v0
    v_lshlrev_b32 v4, 2, v4
    v_mov_b32 v3, 0xffff
    v_lshlrev_b32 v3, v4, v3
    s_mov_b32 s26, 0x3e0293ee
    s_mov_b32 s67, 0x3f803f80
    s_mul_i32 s29, s3, 13312
    s_cmp_ge_u32 s69, 32
    s_cbranch_scc1 L_nocpf
    s_getpc_b64 s[70:71]
L_cpf_pc:
    s_lshr_b32 s72, s69, 3
    s_and_b32 s72, s72, 3
    s_lshl_b32 s72, s72, 2
    s_add_u32 s72, s72, s3
    s_lshl_b32 s72, s72, 10
    v_add_u32 v42, s72, v2
    v_add_u32 v43, 0x4000, v42
    v_min_u32 v42, L_code_end-L_cpf_pc-16, v42
    v_min_u32 v43, L_code_end-L_cpf_pc-16, v43
    global_load_dwordx4 v[44:47], v42, s[70:71]
    global_load_dwordx4 v[48:51], v43, s[70:71]
L_nocpf:
    v_mov_b32 v4, -1
    v_mov_b32 v5, -1
    v_mov_b32 v6, -1
    v_mov_b32 v7, -1
    s_lshl_b32 s70, s3, 18
    s_lshl_b32 s71, s2, 10
    s_add_u32 s70, s70, s71
    buffer_store_dwordx4 v[4:7], v2, s[16:19], s70 offen sc1
    s_lshl_b32 s70, s3, 12
    s_lshl_b32 s71, s4, 7
    s_add_u32 s70, s70, s71
    s_lshl_b32 s71, s6, 2
    s_add_u32 s70, s70, s71
    s_add_u32 s70, s70, 1048576
    v_lshlrev_b32 v8, 6, v0
    s_mov_b64 exec, 3
    buffer_store_dword v4, v8, s[16:19], s70 offen sc1
    s_mov_b64 exec, -1
    s_getreg_b32 s70, hwreg(HW_REG_XCC_ID)
    s_and_b32 s70, s70, 15
    v_mov_b32 v10, s70
    s_lshl_b32 s70, s2, 2
    s_add_u32 s70, s70, 1425408
    v_mov_b32 v11, 0
    s_mov_b64 exec, 1
    buffer_store_dword v10, v11, s[16:19], s70 offen sc1
    s_mov_b64 exec, -1
    global_load_ushort v23, v11, s[50:51]
    s_mul_i32 s7, s4, 9
    s_add_u32 s7, s7, s5
    s_cmp_ge_u32 s5, 9
    s_cbranch_scc1 L_pro_s1
    v_lshlrev_b32 v8, 2, v0
    s_lshl_b32 s70, s3, 16
    s_lshl_b32 s71, s7, 8
    s_add_u32 s70, s70, s71
    s_add_u32 s70, s70, 1114112
    buffer_store_dword v4, v8, s[16:19], s70 offen sc1
    s_lshl_b32 s70, s3, 18
    s_lshl_b32 s71, s7, 10
    s_add_u32 s70, s70, s71
    s_add_u32 s70, s70, 1441792
    buffer_store_dwordx4 v[4:7], v2, s[16:19], s70 offen sc1
    s_lshl_b32 s70, s3, 12
    s_lshl_b32 s71, s7, 4
    s_add_u32 s70, s70, s71
    s_add_u32 s70, s70, 1376256
    s_mov_b64 exec, 15
    buffer_store_dword v4, v8, s[16:19], s70 offen sc1
    s_lshl_b32 s70, s3, 12
    s_lshl_b32 s71, s4, 7
    s_add_u32 s70, s70, s71
    s_add_u32 s70, s70, 1409024
    buffer_store_dword v4, v8, s[16:19], s70 offen sc1
    buffer_store_dword v4, v8, s[16:19], s70 offen offset:2048 sc1
    s_mov_b64 exec, -1
    s_mov_b32 s20, s32
    s_mov_b32 s21, s33
    s_mov_b32 s22, 2304
    v_lshlrev_b32 v9, 3, v0
    v_lshlrev_b32 v10, 1, v0
    buffer_load_dwordx2 v[12:13], v9, s[20:23], 0 offen
    buffer_load_dwordx2 v[14:15], v9, s[20:23], 0 offen offset:512
    buffer_load_ushort v16, v10, s[20:23], 0 offen offset:1024
    buffer_load_dwordx2 v[18:19], v9, s[20:23], 0 offen offset:1152
    buffer_load_dwordx2 v[20:21], v9, s[20:23], 0 offen offset:1664
    buffer_load_ushort v22, v10, s[20:23], 0 offen offset:2176
    s_mov_b32 s20, s38
    s_mov_b32 s21, s39
    s_mov_b32 s22, 4718592
    v_lshrrev_b32 v24, 5, v0
    v_and_b32 v25, 31, v0
    v_lshlrev_b32 v25, 4, v25
    v_lshlrev_b32 v26, 5, v24
    v_xor_b32 v25, v25, v26
    v_lshl_add_u32 v24, v24, 13, v25
    v_xor_b32 v25, 64, v24
    v_xor_b32 v26, 128, v24
    v_xor_b32 v27, 192, v24
    s_lshl_b32 s70, s5, 19
    s_lshl_b32 s71, s3, 17
    s_add_u32 s70, s70, s71
    s_lshl_b32 s71, s4, 9
    s_add_u32 s70, s70, s71
    s_lshl_b32 s71, s3, 13
    s_add_u32 s71, s71, 86016
    s_add_u32 m0, s71, 0
    s_nop 0
    buffer_load_dwordx4 v24, s[20:23], s70 offen nt lds
    s_add_u32 s70, s70, 16384
    s_add_u32 m0, s71, 1024
    s_nop 0
    buffer_load_dwordx4 v25, s[20:23], s70 offen nt lds
    s_add_u32 s70, s70, 16384
    s_add_u32 m0, s71, 2048
    s_nop 0
    buffer_load_dwordx4 v24, s[20:23], s70 offen nt lds
    s_add_u32 s70, s70, 16384
    s_add_u32 m0, s71, 3072
    s_nop 0
    buffer_load_dwordx4 v25, s[20:23], s70 offen nt lds
    s_add_u32 s70, s70, 16384
    s_add_u32 m0, s71, 4096
    s_nop 0
    buffer_load_dwordx4 v26, s[20:23], s70 offen nt lds
    s_add_u32 s70, s70, 16384
    s_add_u32 m0, s71, 5120
    s_nop 0
    buffer_load_dwordx4 v27, s[20:23], s70 offen nt lds
    s_add_u32 s70, s70, 16384
    s_add_u32 m0, s71, 6144
    s_nop 0
    buffer_load_dwordx4 v26, s[20:23], s70 offen nt lds
    s_add_u32 s70, s70, 16384
    s_add_u32 m0, s71, 7168
    s_nop 0
    buffer_load_dwordx4 v27, s[20:23], s70 offen nt lds
L_pro_s1:
    s_mov_b32 s33, 0
    s_cmp_lt_u32 s82, 16
    s_cbranch_scc1 Lt_1
    s_waitcnt vmcnt(0)
Ltb_2:
    v_lshlrev_b32 v23, 16, v23
    s_nop 0
    v_readfirstlane_b32 s78, v23
    s_mov_b32 s56, 118784
    s_cmp_ge_u32 s5, 9
    s_cbranch_scc1 L_pro_s2
    v_add_u32 v24, 146432, v2
    v_lshlrev_b32 v25, 2, v0
    v_add_u32 v25, 148480, v25
    v_lshlrev_b32 v28, 16, v12
    v_and_b32 v29, 0xffff0000, v12
    v_lshlrev_b32 v30, 16, v13
    v_and_b32 v31, 0xffff0000, v13
    v_lshlrev_b32 v32, 16, v14
    v_and_b32 v33, 0xffff0000, v14
    v_lshlrev_b32 v34, 16, v15
    v_and_b32 v35, 0xffff0000, v15
    v_lshlrev_b32 v36, 16, v16
    ds_write_b128 v24, v[28:31] offset:0
    ds_write_b128 v24, v[32:35] offset:1024
    ds_write_b32 v25, v36 offset:0
    s_waitcnt lgkmcnt(0)
    v_lshlrev_b32 v28, 16, v18
    v_and_b32 v29, 0xffff0000, v18
    v_lshlrev_b32 v30, 16, v19
    v_and_b32 v31, 0xffff0000, v19
    v_lshlrev_b32 v32, 16, v20
    v_and_b32 v33, 0xffff0000, v20
    v_lshlrev_b32 v34, 16, v21
    v_and_b32 v35, 0xffff0000, v21
    v_lshlrev_b32 v36, 16, v22
    ds_write_b128 v24, v[28:31] offset:2304
    ds_write_b128 v24, v[32:35] offset:3328
    ds_write_b32 v25, v36 offset:2304
    s_waitcnt lgkmcnt(0)
L_pro_s2:
    s_barrier
    s_cmp_lg_u32 s3, 0
    s_cbranch_scc1 L_pro_arr
    v_mov_b32 v4, 0
    v_mov_b32 v5, 1
    s_mov_b64 exec, 1
    global_atomic_add v6, v4, v5, s[54:55] offset:64 sc0 sc1
    s_mov_b64 exec, -1
    s_cmp_lt_u32 s82, 16
    s_cbranch_scc1 Lt_3
    s_waitcnt vmcnt(0)
Ltb_4:
    v_readfirstlane_b32 s70, v6
    s_nop 0
    s_cmp_lg_u32 s70, 255
    s_cbranch_scc1 L_pro_arr
    s_mov_b64 exec, 1
    global_store_dword v4, v5, s[54:55] offset:128 sc1
    s_mov_b64 exec, -1
L_pro_arr:
    s_cmp_ge_u32 s5, 9
    s_cbranch_scc1 L_pro_s3
    s_mov_b32 s63, 1
    s_mov_b32 s64, 146432
    s_mov_b32 s62, 1441792
    s_call_b64 s[30:31], SUB_CH2
    s_barrier
    s_mov_b32 s63, 1
    s_mov_b32 s64, 148736
    s_mov_b32 s62, 1703936
    s_call_b64 s[30:31], SUB_CH2
    s_mov_b32 s20, s40
    s_mov_b32 s21, s41
    s_mov_b32 s22, 4718592
    v_lshrrev_b32 v24, 3, v0
    v_mul_u32_u24 v24, 1152, v24
    v_and_b32 v25, 7, v0
    v_lshlrev_b32 v25, 4, v25
    v_bfe_u32 v26, v0, 4, 1
    v_lshlrev_b32 v26, 5, v26
    v_xor_b32 v25, v25, v26
    v_xor_b32 v26, 64, v25
    v_add_u32 v25, v25, v24
    v_add_u32 v26, v26, v24
    s_lshl_b32 s70, s4, 2
    s_add_u32 s70, s70, s3
    s_mul_i32 s70, s70, 73728
    s_lshl_b32 s71, s5, 7
    s_add_u32 s70, s70, s71
    s_lshl_b32 s71, s3, 13
    s_add_u32 s71, s71, 53248
    s_add_u32 m0, s71, 0
    s_nop 0
    buffer_load_dwordx4 v25, s[20:23], s70 offen nt lds
    s_add_u32 s70, s70, 9216
    s_add_u32 m0, s71, 1024
    s_nop 0
    buffer_load_dwordx4 v26, s[20:23], s70 offen nt lds
    s_add_u32 s70, s70, 9216
    s_add_u32 m0, s71, 2048
    s_nop 0
    buffer_load_dwordx4 v25, s[20:23], s70 offen nt lds
    s_add_u32 s70, s70, 9216
    s_add_u32 m0, s71, 3072
    s_nop 0
    buffer_load_dwordx4 v26, s[20:23], s70 offen nt lds
    s_add_u32 s70, s70, 9216
    s_add_u32 m0, s71, 4096
    s_nop 0
    buffer_load_dwordx4 v25, s[20:23], s70 offen nt lds
    s_add_u32 s70, s70, 9216
    s_add_u32 m0, s71, 5120
    s_nop 0
    buffer_load_dwordx4 v26, s[20:23], s70 offen nt lds
    s_add_u32 s70, s70, 9216
    s_add_u32 m0, s71, 6144
    s_nop 0
    buffer_load_dwordx4 v25, s[20:23], s70 offen nt lds
    s_add_u32 s70, s70, 9216
    s_add_u32 m0, s71, 7168
    s_nop 0
    buffer_load_dwordx4 v26, s[20:23], s70 offen nt lds
    s_lshl_b32 s70, s3, 10
    v_add_u32 v24, s70, v2
    v_add_u32 v25, 4096, v24
    v_add_u32 v26, 8192, v2
    s_add_u32 s71, s70, 118784
    s_add_u32 m0, s71, 0
    s_nop 0
    global_load_lds_dwordx4 v24, s[44:45]
    s_add_u32 m0, s71, 4096
    s_nop 0
    global_load_lds_dwordx4 v25, s[44:45]
    s_mov_b32 m0, 126976
    s_nop 0
    global_load_lds_dwordx4 v26, s[44:45]
    s_add_u32 m0, s71, 9216
    s_nop 0
    global_load_lds_dwordx4 v24, s[46:47]
    s_add_u32 m0, s71, 13312
    s_nop 0
    global_load_lds_dwordx4 v25, s[46:47]
    s_mov_b32 m0, 136192
    s_nop 0
    global_load_lds_dwordx4 v26, s[46:47]
    s_add_u32 m0, s71, 18432
    s_nop 0
    global_load_lds_dwordx4 v24, s[48:49]
    s_add_u32 m0, s71, 22528
    s_nop 0
    global_load_lds_dwordx4 v25, s[48:49]
    s_mov_b32 m0, 145408
    s_nop 0
    global_load_lds_dwordx4 v26, s[48:49]
L_pro_s3:
    s_cmp_lt_u32 s82, 16
    s_cbranch_scc1 Lt_5
Ltb_6:
    v_mov_b32 v4, 0
    s_mov_b32 s68, 0
Lpoll_7:
    global_load_dword v5, v4, s[54:55] offset:128 sc1
    s_cmp_lt_u32 s82, 16
    s_cbranch_scc1 Lt_10
    s_waitcnt vmcnt(0)
Ltb_11:
    v_cmp_eq_u32 vcc, 0, v5
    s_cbranch_vccnz Lpr_9
Lpd_8:
    s_lshl_b32 s70, s3, 8
    v_lshl_add_u32 v22, v0, 2, s70
    s_mul_i32 s69, s4, 9216
    s_add_u32 s70, s69, 1441792
    s_add_u32 s71, s70, 4096
    s_add_u32 s72, s70, 8192
    s_add_u32 s73, s69, 1703936
    s_add_u32 s74, s73, 4096
    s_add_u32 s75, s73, 8192
    v_lshrrev_b32 v24, 1, v22
    v_add_u32 v24, 160256, v24
    s_lshl_b32 s76, s4, 6
    s_add_u32 s76, s76, 1425408
    v_and_b32 v25, 15, v0
    v_lshlrev_b32 v25, 2, v25
    s_mov_b32 s68, 0
Lpoll_12:
    buffer_load_dword v26, v25, s[16:19], s76 offen sc1
    buffer_load_dword v4, v22, s[16:19], s70 offen offset:0 sc1
    buffer_load_dword v5, v22, s[16:19], s70 offen offset:1024 sc1
    buffer_load_dword v6, v22, s[16:19], s70 offen offset:2048 sc1
    buffer_load_dword v7, v22, s[16:19], s70 offen offset:3072 sc1
    buffer_load_dword v8, v22, s[16:19], s71 offen offset:0 sc1
    buffer_load_dword v9, v22, s[16:19], s71 offen offset:1024 sc1
    buffer_load_dword v10, v22, s[16:19], s71 offen offset:2048 sc1
    buffer_load_dword v11, v22, s[16:19], s71 offen offset:3072 sc1
    buffer_load_dword v12, v22, s[16:19], s72 offen offset:0 sc1
    buffer_load_dword v13, v22, s[16:19], s73 offen offset:0 sc1
    buffer_load_dword v14, v22, s[16:19], s73 offen offset:1024 sc1
    buffer_load_dword v15, v22, s[16:19], s73 offen offset:2048 sc1
    buffer_load_dword v16, v22, s[16:19], s73 offen offset:3072 sc1
    buffer_load_dword v17, v22, s[16:19], s74 offen offset:0 sc1
    buffer_load_dword v18, v22, s[16:19], s74 offen offset:1024 sc1
    buffer_load_dword v19, v22, s[16:19], s74 offen offset:2048 sc1
    buffer_load_dword v20, v22, s[16:19], s74 offen offset:3072 sc1
    buffer_load_dword v21, v22, s[16:19], s75 offen offset:0 sc1
    s_cmp_lt_u32 s82, 16
    s_cbranch_scc1 Lt_15
    s_waitcnt vmcnt(0)
Ltb_16:
    v_max_u32 v23, v4, v5
    v_max3_u32 v23, v23, v6, v7
    v_max3_u32 v23, v23, v8, v9
    v_max3_u32 v23, v23, v10, v11
    v_max3_u32 v23, v23, v12, v13
    v_max3_u32 v23, v23, v14, v15
    v_max3_u32 v23, v23, v16, v17
    v_max3_u32 v23, v23, v18, v19
    v_max3_u32 v23, v23, v20, v21
    v_cmp_eq_u32 vcc, -1, v23
    s_cbranch_vccnz Lpr_14
Lpd_13:
    v_readfirstlane_b32 s70, v26
    s_nop 1
    v_cmp_ne_u32 vcc, s70, v26
    s_nop 0
    s_cmp_eq_u64 vcc, 0
    s_cselect_b32 s33, 1, 0
    v_add_f32 v4, v4, v5
    v_add_f32 v6, v6, v7
    v_add_f32 v8, v8, v9
    v_add_f32 v10, v10, v11
    v_add_f32 v4, v4, v6
    v_add_f32 v8, v8, v10
    v_add_f32 v4, v4, v12
    v_add_f32 v4, v4, v8
    v_cvt_pk_bf16_f32 v4, v4, v4
    v_add_f32 v13, v13, v14
    v_add_f32 v15, v15, v16
    v_add_f32 v17, v17, v18
    v_add_f32 v19, v19, v20
    v_add_f32 v13, v13, v15
    v_add_f32 v17, v17, v19
    v_add_f32 v13, v13, v21
    v_add_f32 v13, v13, v17
    v_cvt_pk_bf16_f32 v13, v13, v13
    ds_write_b16 v24, v4
    ds_write_b16 v24, v13 offset:512
Lrest_17:
    s_cmp_ge_u32 s82, 10
    s_cbranch_scc1 Lrd_18
    s_call_b64 s[80:81], SUB_LN
    s_branch Lrest_17
Lrd_18:
    s_waitcnt lgkmcnt(0)
    s_barrier
    s_cmp_eq_u32 s3, 0
    s_cselect_b32 s63, 4, 0
    s_lshl_b32 s60, s4, 7
    s_add_u32 s60, s60, 1417220
    s_mov_b32 s58, 0
    s_mov_b32 s59, 1048576
    s_mov_b32 s65, 160256
    s_mov_b32 s64, 151040
    s_lshl_b32 s62, s4, 7
    s_add_u32 s62, s62, 1411072
    s_mov_b64 vcc, -1
    s_call_b64 s[30:31], SUB_ATT
    s_add_u32 s27, s27, 0x4000000
    s_cmp_ge_u32 s5, 9
    s_cbranch_scc1 L_srole
    s_mov_b32 s42, 0
    s_mov_b32 s58, 0
    s_mov_b32 s59, 1048576
    s_mov_b32 s60, 1114112
    s_mov_b32 s64, 146432
    s_mov_b32 s63, 0
    s_mov_b32 s61, 1376256
    s_call_b64 s[30:31], SUB_CH1
    s_mov_b32 s63, 0
    s_mov_b32 s61, 1376256
    s_mov_b32 s64, 146432
    s_mov_b32 s62, 1966080
    s_call_b64 s[30:31], SUB_CH2
    s_xor_b32 s69, s33, 1
    s_mov_b32 s58, 524288
    s_mov_b32 s59, 1056768
    s_mov_b32 s65, 161280
    s_mov_b32 s64, 155264
    s_mov_b32 s62, 1966080
    s_mov_b32 s63, 2
    s_call_b64 s[30:31], SUB_QATT
Lrest_19:
    s_cmp_ge_u32 s82, 3
    s_cbranch_scc1 Lrd_20
    s_call_b64 s[80:81], SUB_LN
    s_branch Lrest_19
Lrd_20:
    s_mov_b32 s58, 524288
    s_mov_b32 s59, 1056768
    s_mov_b32 s60, 1245184
    s_mov_b32 s64, 146432
    s_mov_b32 s63, 2
    s_mov_b32 s61, 0
    s_call_b64 s[30:31], SUB_CH1
    s_or_b32 s70, s5, s3
    s_cbranch_scc1 L_nf3
    s_lshl_b32 s70, s4, 7
    s_add_u32 s70, s70, 1421312
    s_mov_b64 exec, 1
    buffer_store_dword v2, v2, s[16:19], s70 offen sc1
    s_mov_b64 exec, -1
L_nf3:
Lrest_21:
    s_cmp_ge_u32 s82, 10
    s_cbranch_scc1 Lrd_22
    s_call_b64 s[80:81], SUB_LN
    s_branch Lrest_21
Lrd_22:
    s_cmp_eq_u32 s3, 0
    s_cselect_b32 s63, 3, 0
    s_lshl_b32 s60, s4, 7
    s_add_u32 s60, s60, 1417216
    s_mov_b32 s58, 262144
    s_mov_b32 s59, 1052672
    s_mov_b32 s65, 160768
    s_mov_b32 s64, 151040
    s_lshl_b32 s62, s4, 7
    s_add_u32 s62, s62, 1415168
    s_mov_b64 vcc, -1
    s_call_b64 s[30:31], SUB_ATT
    s_mov_b32 s79, 1
    s_mov_b32 s58, 262144
    s_mov_b32 s59, 1052672
    s_mov_b32 s60, 1179648
    s_mov_b32 s64, 148736
    s_mov_b32 s63, 0
    s_mov_b32 s61, 1380352
    s_call_b64 s[30:31], SUB_CH1
    s_mov_b32 s63, 0
    s_mov_b32 s61, 1380352
    s_mov_b32 s64, 148736
    s_mov_b32 s62, 2228224
    s_call_b64 s[30:31], SUB_CH2
    s_mov_b32 s58, 786432
    s_mov_b32 s59, 1060864
    s_mov_b32 s65, 161792
    s_mov_b32 s64, 155264
    s_mov_b32 s62, 2228224
    s_mov_b32 s63, 0
    s_call_b64 s[30:31], SUB_QATT
    s_mov_b32 s79, 2
    s_mov_b32 s58, 786432
    s_mov_b32 s59, 1060864
    s_mov_b32 s60, 1310720
    s_mov_b32 s64, 148736
    s_mov_b32 s63, 1
    s_mov_b32 s61, 1152
    s_call_b64 s[30:31], SUB_CH1
    s_branch L_fin
L_srole:
    s_mov_b32 s42, 0
    s_mov_b32 s69, 0
    s_mul_i32 s57, s3, 20480
    s_add_u32 s57, s57, 53248
    s_lshl_b32 s70, s4, 7
    s_add_u32 s70, s70, 1417220
    v_mov_b32 v4, 0
    s_mov_b32 s68, 0
    s_cmp_lg_u32 s3, 0
    s_cbranch_scc1 Lhd_24
Lh_23:
    buffer_load_dword v5, v4, s[16:19], s70 offen sc1
    s_waitcnt vmcnt(0)
    v_cmp_gt_i32 vcc, 1048559, v5
    s_cbranch_vccz Lhd_24
    s_sleep 2
    s_add_u32 s68, s68, 1
    s_cmp_lt_u32 s68, 400000
    s_cbranch_scc1 Lh_23
Lhd_24:
    s_barrier
    s_mov_b32 s58, 262144
    s_mov_b32 s59, 1052672
    s_mov_b32 s65, 160768
    s_mov_b32 s64, 155264
    s_call_b64 s[30:31], SUB_RING
    s_lshl_b32 s70, s4, 7
    s_add_u32 s70, s70, 1409024
    v_mov_b32 v4, 0
    s_mov_b32 s68, 0
    s_cmp_lg_u32 s3, 0
    s_cbranch_scc1 Lhd_26
Lh_25:
    buffer_load_dword v5, v4, s[16:19], s70 offen sc1
    s_waitcnt vmcnt(0)
    v_cmp_eq_u32 vcc, -1, v5
    s_cbranch_vccz Lhd_26
    s_sleep 2
    s_add_u32 s68, s68, 1
    s_cmp_lt_u32 s68, 400000
    s_cbranch_scc1 Lh_25
Lhd_26:
    s_barrier
    s_mov_b32 s58, 524288
    s_mov_b32 s59, 1056768
    s_mov_b32 s65, 161280
    s_mov_b32 s64, 151040
    s_mov_b32 s62, 1966080
    s_mov_b32 s63, 0
    s_call_b64 s[30:31], SUB_QATT
    s_mov_b32 s58, 262144
    s_mov_b32 s59, 1052672
    s_mov_b32 s65, 160768
    s_mov_b32 s64, 155264
    s_lshl_b32 s62, s4, 7
    s_add_u32 s62, s62, 1415168
    s_mov_b32 s63, 0
    s_call_b64 s[30:31], SUB_RESUME
    s_lshl_b32 s70, s3, 10
    v_add_u32 v24, s70, v2
    v_add_u32 v25, 4096, v24
    v_add_u32 v26, 8192, v2
    s_add_u32 s71, s70, 0
    s_add_u32 m0, s71, 0
    s_nop 0
    global_load_lds_dwordx4 v24, s[44:45]
    s_add_u32 m0, s71, 4096
    s_nop 0
    global_load_lds_dwordx4 v25, s[44:45]
    s_mov_b32 m0, 8192
    s_nop 0
    global_load_lds_dwordx4 v26, s[44:45]
    s_add_u32 m0, s71, 9216
    s_nop 0
    global_load_lds_dwordx4 v24, s[46:47]
    s_add_u32 m0, s71, 13312
    s_nop 0
    global_load_lds_dwordx4 v25, s[46:47]
    s_mov_b32 m0, 17408
    s_nop 0
    global_load_lds_dwordx4 v26, s[46:47]
    s_add_u32 m0, s71, 18432
    s_nop 0
    global_load_lds_dwordx4 v24, s[48:49]
    s_add_u32 m0, s71, 22528
    s_nop 0
    global_load_lds_dwordx4 v25, s[48:49]
    s_mov_b32 m0, 26624
    s_nop 0
    global_load_lds_dwordx4 v26, s[48:49]
    s_mov_b32 s56, 0
    s_mov_b32 s70, 1376256
    v_lshlrev_b32 v13, 2, v0
    v_add_u32 v14, 146432, v2
    s_mul_i32 s7, s4, 7
    s_add_u32 s7, s7, s5
    s_sub_u32 s7, s7, 9
    s_mov_b32 s68, 0
Lpoll_27:
    buffer_load_dwordx4 v[4:7], v2, s[16:19], s70 offen sc1
    buffer_load_dwordx4 v[8:11], v2, s[16:19], s70 offen offset:1024 sc1
    buffer_load_dword v12, v13, s[16:19], s70 offen offset:2048 sc1
    s_cmp_lt_u32 s82, 16
    s_cbranch_scc1 Lt_30
    s_waitcnt vmcnt(0)
Ltb_31:
    v_max3_u32 v15, v4, v5, v6
    v_max3_u32 v15, v15, v7, v8
    v_max3_u32 v15, v15, v9, v10
    v_max3_u32 v15, v15, v11, v12
    v_cmp_eq_u32 vcc, -1, v15
    s_cbranch_vccnz Lpr_29
Lpd_28:
    v_add_u32 v13, 146432, v13
    ds_write_b128 v14, v[4:7]
    ds_write_b128 v14, v[8:11] offset:1024
    ds_write_b32 v13, v12 offset:2048
    s_lshl_b32 s70, s4, 7
    s_add_u32 s70, s70, 1421312
    v_mov_b32 v4, 0
    s_mov_b32 s68, 0
    s_cmp_lg_u32 s3, 0
    s_cbranch_scc1 Lhd_33
Lh_32:
    buffer_load_dword v5, v4, s[16:19], s70 offen sc1
    s_waitcnt vmcnt(0)
    v_cmp_eq_u32 vcc, -1, v5
    s_cbranch_vccz Lhd_33
    s_sleep 8
    s_add_u32 s68, s68, 1
    s_cmp_lt_u32 s68, 400000
    s_cbranch_scc1 Lh_32
Lhd_33:
    s_barrier
    s_mov_b32 s58, 524288
    s_mov_b32 s59, 1056768
    s_mov_b32 s60, 1245184
    s_mov_b32 s64, 146432
    s_mov_b32 s63, 1
    s_mov_b32 s61, 0
    s_call_b64 s[30:31], SUB_CH1B
    s_mov_b32 s82, 0
Lrest_34:
    s_cmp_ge_u32 s82, 8
    s_cbranch_scc1 Lrd_35
    s_call_b64 s[80:81], SUB_LN
    s_branch Lrest_34
Lrd_35:
    s_add_u32 s28, s27, 0
    buffer_load_dwordx4 v[56:59], v2, s[12:15], s28 offen offset:2048 nt
    buffer_load_dwordx4 v[60:63], v2, s[12:15], s28 offen offset:3072 nt
    s_add_u32 s28, s27, 4096
    buffer_load_dwordx4 v[64:67], v2, s[12:15], s28 offen offset:2048 nt
    buffer_load_dwordx4 v[68:71], v2, s[12:15], s28 offen offset:3072 nt
    s_add_u32 s28, s27, 8192
    buffer_load_dwordx4 v[72:75], v2, s[12:15], s28 offen offset:2048 nt
    buffer_load_dwordx4 v[76:79], v2, s[12:15], s28 offen offset:3072 nt
    s_add_u32 s28, s27, 12288
    buffer_load_dwordx4 v[80:83], v2, s[12:15], s28 offen offset:2048 nt
    buffer_load_dwordx4 v[84:87], v2, s[12:15], s28 offen offset:3072 nt
    s_add_u32 s28, s27, 16384
    buffer_load_dwordx4 v[88:91], v2, s[12:15], s28 offen offset:2048 nt
    buffer_load_dwordx4 v[92:95], v2, s[12:15], s28 offen offset:3072 nt
    s_add_u32 s28, s27, 20480
    buffer_load_dwordx4 v[96:99], v2, s[12:15], s28 offen offset:2048 nt
    buffer_load_dwordx4 v[100:103], v2, s[12:15], s28 offen offset:3072 nt
    s_add_u32 s28, s27, 24576
    buffer_load_dwordx4 v[52:55], v2, s[12:15], s28 offen offset:1024 nt
    buffer_load_dwordx4 v[104:107], v2, s[12:15], s28 offen offset:2048 nt
    buffer_load_dwordx4 v[108:111], v2, s[12:15], s28 offen offset:3072 nt
    s_add_u32 s28, s27, 28672
    buffer_load_dwordx4 v[112:115], v2, s[12:15], s28 offen offset:0 nt
    buffer_load_dwordx4 v[116:119], v2, s[12:15], s28 offen offset:1024 nt
    buffer_load_dwordx4 v[120:123], v2, s[12:15], s28 offen offset:2048 nt
    buffer_load_dwordx4 v[124:127], v2, s[12:15], s28 offen offset:3072 nt
    s_add_u32 s28, s27, 32768
    buffer_load_dwordx4 v[128:131], v2, s[12:15], s28 offen offset:0 nt
    buffer_load_dwordx4 v[132:135], v2, s[12:15], s28 offen offset:1024 nt
    buffer_load_dwordx4 v[136:139], v2, s[12:15], s28 offen offset:2048 nt
    buffer_load_dwordx4 v[140:143], v2, s[12:15], s28 offen offset:3072 nt
    s_add_u32 s28, s27, 36864
    buffer_load_dwordx4 v[144:147], v2, s[12:15], s28 offen offset:0 nt
    buffer_load_dwordx4 v[148:151], v2, s[12:15], s28 offen offset:1024 nt
    buffer_load_dwordx4 v[152:155], v2, s[12:15], s28 offen offset:2048 nt
    buffer_load_dwordx4 v[156:159], v2, s[12:15], s28 offen offset:3072 nt
    s_mov_b32 s29, s57
    s_mov_b32 s82, 16
    s_lshl_b32 s70, s4, 7
    s_add_u32 s70, s70, 1413120
    v_mov_b32 v4, 0
    s_mov_b32 s68, 0
    s_cmp_lg_u32 s3, 0
    s_cbranch_scc1 Lhd_37
Lh_36:
    buffer_load_dword v5, v4, s[16:19], s70 offen sc1
    s_waitcnt vmcnt(0)
    v_cmp_eq_u32 vcc, -1, v5
    s_cbranch_vccz Lhd_37
    s_sleep 2
    s_add_u32 s68, s68, 1
    s_cmp_lt_u32 s68, 400000
    s_cbranch_scc1 Lh_36
Lhd_37:
    s_barrier
    s_mov_b32 s58, 786432
    s_mov_b32 s59, 1060864
    s_mov_b32 s65, 161792
    s_mov_b32 s64, 151040
    s_mov_b32 s62, 2228224
    s_mov_b32 s63, 0
    s_call_b64 s[30:31], SUB_QATT
    s_add_u32 s7, s7, 112
    s_cmp_ge_u32 s7, 144
    s_cbranch_scc1 L_s_nf
    s_mov_b32 s58, 524288
    s_mov_b32 s59, 1056768
    s_mov_b32 s60, 1245184
    s_mov_b32 s64, 146432
    s_mov_b32 s63, 1
    s_mov_b32 s61, 0
    s_call_b64 s[30:31], SUB_CH1B
L_s_nf:
L_fin:
    s_waitcnt vmcnt(0)
L_end:
    s_endpgm
SUB_ATT:
    v_bfe_u32 v15, v0, 1, 1
    v_lshlrev_b32 v12, 8, v15
    v_lshrrev_b32 v13, 4, v0
    v_lshl_add_u32 v12, v13, 5, v12
    v_and_b32 v14, 1, v0
    v_lshl_add_u32 v12, v14, 4, v12
    v_add_u32 v12, s65, v12
    v_bfe_u32 v15, v0, 4, 1
    v_lshlrev_b32 v47, 9, v15
    v_and_b32 v15, 15, v0
    v_lshl_add_u32 v47, v15, 5, v47
    v_lshrrev_b32 v15, 5, v0
    v_lshl_add_u32 v47, v15, 4, v47
    s_lshl_b32 s70, s3, 10
    s_add_u32 s70, s70, s64
    v_add_u32 v47, s70, v47
    v_mov_b32 v34, 0
    v_mov_b32 v35, 0
    v_mov_b32 v36, 0
    v_mov_b32 v37, 0
    v_mov_b32 v38, 0
    v_mov_b32 v39, 0
    v_mov_b32 v40, 0
    v_mov_b32 v41, 0
    v_mov_b32 v42, 0
    v_mov_b32 v43, 0
    v_mov_b32 v44, 0
    v_mov_b32 v45, 0
    ds_read_b128 v[4:7], v12
    ds_read_b128 v[8:11], v12 offset:128
    s_waitcnt vmcnt(16) lgkmcnt(0)
    v_mfma_f32_16x16x32_bf16 v[12:15], v[4:7], a[0:3], 0
    v_mfma_f32_16x16x32_bf16 v[12:15], v[8:11], a[4:7], v[12:15]
    s_cmp_ge_u32 s82, 16
    s_cbranch_scc1 Lki_38
    s_call_b64 s[80:81], SUB_LN
Lki_38:
    v_mfma_f32_16x16x32_bf16 v[16:19], v[4:7], a[8:11], 0
    v_mfma_f32_16x16x32_bf16 v[16:19], v[8:11], a[12:15], v[16:19]
    v_mfma_f32_16x16x32_bf16 v[20:23], v[4:7], a[16:19], 0
    v_mfma_f32_16x16x32_bf16 v[20:23], v[8:11], a[20:23], v[20:23]
    s_nop 0
    v_add_f32_dpp v32, v13, v12 quad_perm:[1,0,3,2] row_mask:0x1 bank_mask:0xf
    v_add_f32_dpp v33, v14, v15 quad_perm:[1,0,3,2] row_mask:0x1 bank_mask:0xf
    v_mfma_f32_16x16x32_bf16 v[12:15], v[4:7], a[24:27], 0
    v_mfma_f32_16x16x32_bf16 v[12:15], v[8:11], a[28:31], v[12:15]
    s_nop 0
    v_add_f32_dpp v32, v17, v16 quad_perm:[1,0,3,2] row_mask:0x2 bank_mask:0xf
    v_add_f32_dpp v33, v18, v19 quad_perm:[1,0,3,2] row_mask:0x2 bank_mask:0xf
    v_mfma_f32_16x16x32_bf16 v[16:19], v[4:7], a[32:35], 0
    v_mfma_f32_16x16x32_bf16 v[16:19], v[8:11], a[36:39], v[16:19]
    v_add_f32_dpp v32, v21, v20 quad_perm:[1,0,3,2] row_mask:0x4 bank_mask:0xf
    v_add_f32_dpp v33, v22, v23 quad_perm:[1,0,3,2] row_mask:0x4 bank_mask:0xf
    v_mfma_f32_16x16x32_bf16 v[20:23], v[4:7], a[40:43], 0
    v_mfma_f32_16x16x32_bf16 v[20:23], v[8:11], a[44:47], v[20:23]
    v_add_f32_dpp v32, v13, v12 quad_perm:[1,0,3,2] row_mask:0x8 bank_mask:0xf
    v_add_f32_dpp v33, v14, v15 quad_perm:[1,0,3,2] row_mask:0x8 bank_mask:0xf
    v_cndmask_b32 v24, v32, v33, s[24:25]
    v_mfma_f32_16x16x32_bf16 v[12:15], v[4:7], a[48:51], 0
    v_mfma_f32_16x16x32_bf16 v[12:15], v[8:11], a[52:55], v[12:15]
    v_add_f32_dpp v32, v17, v16 quad_perm:[1,0,3,2] row_mask:0x1 bank_mask:0xf
    v_add_f32_dpp v33, v18, v19 quad_perm:[1,0,3,2] row_mask:0x1 bank_mask:0xf
    v_mfma_f32_16x16x32_bf16 v[16:19], v[4:7], a[56:59], 0
    v_mfma_f32_16x16x32_bf16 v[16:19], v[8:11], a[60:63], v[16:19]
    v_add_f32_dpp v32, v21, v20 quad_perm:[1,0,3,2] row_mask:0x2 bank_mask:0xf
    v_add_f32_dpp v33, v22, v23 quad_perm:[1,0,3,2] row_mask:0x2 bank_mask:0xf
    v_mfma_f32_16x16x32_bf16 v[20:23], v[4:7], a[64:67], 0
    v_mfma_f32_16x16x32_bf16 v[20:23], v[8:11], a[68:71], v[20:23]
    v_add_f32_dpp v32, v13, v12 quad_perm:[1,0,3,2] row_mask:0x4 bank_mask:0xf
    v_add_f32_dpp v33, v14, v15 quad_perm:[1,0,3,2] row_mask:0x4 bank_mask:0xf
    v_mfma_f32_16x16x32_bf16 v[12:15], v[4:7], a[72:75], 0
    v_mfma_f32_16x16x32_bf16 v[12:15], v[8:11], a[76:79], v[12:15]
    v_add_f32_dpp v32, v17, v16 quad_perm:[1,0,3,2] row_mask:0x8 bank_mask:0xf
    v_add_f32_dpp v33, v18, v19 quad_perm:[1,0,3,2] row_mask:0x8 bank_mask:0xf
    v_cndmask_b32 v25, v32, v33, s[24:25]
    v_max_f32 v46, v24, v25
    v_mfma_f32_16x16x32_bf16 v[16:19], v[4:7], a[80:83], 0
    v_mfma_f32_16x16x32_bf16 v[16:19], v[8:11], a[84:87], v[16:19]
    v_add_f32_dpp v32, v21, v20 quad_perm:[1,0,3,2] row_mask:0x1 bank_mask:0xf
    v_add_f32_dpp v33, v22, v23 quad_perm:[1,0,3,2] row_mask:0x1 bank_mask:0xf
    v_mfma_f32_16x16x32_bf16 v[20:23], v[4:7], a[88:91], 0
    v_mfma_f32_16x16x32_bf16 v[20:23], v[8:11], a[92:95], v[20:23]
    v_add_f32_dpp v32, v13, v12 quad_perm:[1,0,3,2] row_mask:0x2 bank_mask:0xf
    v_add_f32_dpp v33, v14, v15 quad_perm:[1,0,3,2] row_mask:0x2 bank_mask:0xf
    v_mfma_f32_16x16x32_bf16 v[12:15], v[4:7], a[96:99], 0
    v_mfma_f32_16x16x32_bf16 v[12:15], v[8:11], a[100:103], v[12:15]
    v_add_f32_dpp v32, v17, v16 quad_perm:[1,0,3,2] row_mask:0x4 bank_mask:0xf
    v_add_f32_dpp v33, v18, v19 quad_perm:[1,0,3,2] row_mask:0x4 bank_mask:0xf
    v_mfma_f32_16x16x32_bf16 v[16:19], v[4:7], a[104:107], 0
    v_mfma_f32_16x16x32_bf16 v[16:19], v[8:11], a[108:111], v[16:19]
    v_add_f32_dpp v32, v21, v20 quad_perm:[1,0,3,2] row_mask:0x8 bank_mask:0xf
    v_add_f32_dpp v33, v22, v23 quad_perm:[1,0,3,2] row_mask:0x8 bank_mask:0xf
    v_cndmask_b32 v26, v32, v33, s[24:25]
    v_mfma_f32_16x16x32_bf16 v[20:23], v[4:7], a[112:115], 0
    v_mfma_f32_16x16x32_bf16 v[20:23], v[8:11], a[116:119], v[20:23]
    v_add_f32_dpp v32, v13, v12 quad_perm:[1,0,3,2] row_mask:0x1 bank_mask:0xf
    v_add_f32_dpp v33, v14, v15 quad_perm:[1,0,3,2] row_mask:0x1 bank_mask:0xf
    v_mfma_f32_16x16x32_bf16 v[12:15], v[4:7], a[120:123], 0
    v_mfma_f32_16x16x32_bf16 v[12:15], v[8:11], a[124:127], v[12:15]
    v_add_f32_dpp v32, v17, v16 quad_perm:[1,0,3,2] row_mask:0x2 bank_mask:0xf
    v_add_f32_dpp v33, v18, v19 quad_perm:[1,0,3,2] row_mask:0x2 bank_mask:0xf
    s_cmp_ge_u32 s82, 16
    s_cbranch_scc1 Lki_39
    s_call_b64 s[80:81], SUB_LN
Lki_39:
    v_mfma_f32_16x16x32_bf16 v[16:19], v[4:7], a[128:131], 0
    v_mfma_f32_16x16x32_bf16 v[16:19], v[8:11], a[132:135], v[16:19]
    v_add_f32_dpp v32, v21, v20 quad_perm:[1,0,3,2] row_mask:0x4 bank_mask:0xf
    v_add_f32_dpp v33, v22, v23 quad_perm:[1,0,3,2] row_mask:0x4 bank_mask:0xf
    v_mfma_f32_16x16x32_bf16 v[20:23], v[4:7], a[136:139], 0
    v_mfma_f32_16x16x32_bf16 v[20:23], v[8:11], a[140:143], v[20:23]
    v_add_f32_dpp v32, v13, v12 quad_perm:[1,0,3,2] row_mask:0x8 bank_mask:0xf
    v_add_f32_dpp v33, v14, v15 quad_perm:[1,0,3,2] row_mask:0x8 bank_mask:0xf
    v_cndmask_b32 v27, v32, v33, s[24:25]
    v_max3_f32 v46, v46, v26, v27
    v_mfma_f32_16x16x32_bf16 v[12:15], v[4:7], a[144:147], 0
    v_mfma_f32_16x16x32_bf16 v[12:15], v[8:11], a[148:151], v[12:15]
    v_add_f32_dpp v32, v17, v16 quad_perm:[1,0,3,2] row_mask:0x1 bank_mask:0xf
    v_add_f32_dpp v33, v18, v19 quad_perm:[1,0,3,2] row_mask:0x1 bank_mask:0xf
    v_mfma_f32_16x16x32_bf16 v[16:19], v[4:7], a[152:155], 0
    v_mfma_f32_16x16x32_bf16 v[16:19], v[8:11], a[156:159], v[16:19]
    v_add_f32_dpp v32, v21, v20 quad_perm:[1,0,3,2] row_mask:0x2 bank_mask:0xf
    v_add_f32_dpp v33, v22, v23 quad_perm:[1,0,3,2] row_mask:0x2 bank_mask:0xf
    v_mfma_f32_16x16x32_bf16 v[20:23], v[4:7], a[160:163], 0
    v_mfma_f32_16x16x32_bf16 v[20:23], v[8:11], a[164:167], v[20:23]
    v_add_f32_dpp v32, v13, v12 quad_perm:[1,0,3,2] row_mask:0x4 bank_mask:0xf
    v_add_f32_dpp v33, v14, v15 quad_perm:[1,0,3,2] row_mask:0x4 bank_mask:0xf
    v_mfma_f32_16x16x32_bf16 v[12:15], v[4:7], a[168:171], 0
    v_mfma_f32_16x16x32_bf16 v[12:15], v[8:11], a[172:175], v[12:15]
    v_add_f32_dpp v32, v17, v16 quad_perm:[1,0,3,2] row_mask:0x8 bank_mask:0xf
    v_add_f32_dpp v33, v18, v19 quad_perm:[1,0,3,2] row_mask:0x8 bank_mask:0xf
    v_cndmask_b32 v28, v32, v33, s[24:25]
    v_mfma_f32_16x16x32_bf16 v[16:19], v[4:7], a[176:179], 0
    v_mfma_f32_16x16x32_bf16 v[16:19], v[8:11], a[180:183], v[16:19]
    v_add_f32_dpp v32, v21, v20 quad_perm:[1,0,3,2] row_mask:0x1 bank_mask:0xf
    v_add_f32_dpp v33, v22, v23 quad_perm:[1,0,3,2] row_mask:0x1 bank_mask:0xf
    v_mfma_f32_16x16x32_bf16 v[20:23], v[4:7], a[184:187], 0
    v_mfma_f32_16x16x32_bf16 v[20:23], v[8:11], a[188:191], v[20:23]
    v_add_f32_dpp v32, v13, v12 quad_perm:[1,0,3,2] row_mask:0x2 bank_mask:0xf
    v_add_f32_dpp v33, v14, v15 quad_perm:[1,0,3,2] row_mask:0x2 bank_mask:0xf
    v_mfma_f32_16x16x32_bf16 v[12:15], v[4:7], a[192:195], 0
    v_mfma_f32_16x16x32_bf16 v[12:15], v[8:11], a[196:199], v[12:15]
    v_add_f32_dpp v32, v17, v16 quad_perm:[1,0,3,2] row_mask:0x4 bank_mask:0xf
    v_add_f32_dpp v33, v18, v19 quad_perm:[1,0,3,2] row_mask:0x4 bank_mask:0xf
    v_mfma_f32_16x16x32_bf16 v[16:19], v[4:7], a[200:203], 0
    v_mfma_f32_16x16x32_bf16 v[16:19], v[8:11], a[204:207], v[16:19]
    v_add_f32_dpp v32, v21, v20 quad_perm:[1,0,3,2] row_mask:0x8 bank_mask:0xf
    v_add_f32_dpp v33, v22, v23 quad_perm:[1,0,3,2] row_mask:0x8 bank_mask:0xf
    v_cndmask_b32 v29, v32, v33, s[24:25]
    v_max3_f32 v46, v46, v28, v29
    v_mfma_f32_16x16x32_bf16 v[20:23], v[4:7], a[208:211], 0
    v_mfma_f32_16x16x32_bf16 v[20:23], v[8:11], a[212:215], v[20:23]
    v_add_f32_dpp v32, v13, v12 quad_perm:[1,0,3,2] row_mask:0x1 bank_mask:0xf
    v_add_f32_dpp v33, v14, v15 quad_perm:[1,0,3,2] row_mask:0x1 bank_mask:0xf
    v_mfma_f32_16x16x32_bf16 v[12:15], v[4:7], a[216:219], 0
    v_mfma_f32_16x16x32_bf16 v[12:15], v[8:11], a[220:223], v[12:15]
    v_add_f32_dpp v32, v17, v16 quad_perm:[1,0,3,2] row_mask:0x2 bank_mask:0xf
    v_add_f32_dpp v33, v18, v19 quad_perm:[1,0,3,2] row_mask:0x2 bank_mask:0xf
    v_mfma_f32_16x16x32_bf16 v[16:19], v[4:7], a[224:227], 0
    v_mfma_f32_16x16x32_bf16 v[16:19], v[8:11], a[228:231], v[16:19]
    v_add_f32_dpp v32, v21, v20 quad_perm:[1,0,3,2] row_mask:0x4 bank_mask:0xf
    v_add_f32_dpp v33, v22, v23 quad_perm:[1,0,3,2] row_mask:0x4 bank_mask:0xf
    v_mfma_f32_16x16x32_bf16 v[20:23], v[4:7], a[232:235], 0
    v_mfma_f32_16x16x32_bf16 v[20:23], v[8:11], a[236:239], v[20:23]
    v_add_f32_dpp v32, v13, v12 quad_perm:[1,0,3,2] row_mask:0x8 bank_mask:0xf
    v_add_f32_dpp v33, v14, v15 quad_perm:[1,0,3,2] row_mask:0x8 bank_mask:0xf
    v_cndmask_b32 v30, v32, v33, s[24:25]
    v_mfma_f32_16x16x32_bf16 v[12:15], v[4:7], a[240:243], 0
    v_mfma_f32_16x16x32_bf16 v[12:15], v[8:11], a[244:247], v[12:15]
    v_add_f32_dpp v32, v17, v16 quad_perm:[1,0,3,2] row_mask:0x1 bank_mask:0xf
    v_add_f32_dpp v33, v18, v19 quad_perm:[1,0,3,2] row_mask:0x1 bank_mask:0xf
    v_mfma_f32_16x16x32_bf16 v[16:19], v[4:7], a[248:251], 0
    v_mfma_f32_16x16x32_bf16 v[16:19], v[8:11], a[252:255], v[16:19]
    v_add_f32_dpp v32, v21, v20 quad_perm:[1,0,3,2] row_mask:0x2 bank_mask:0xf
    v_add_f32_dpp v33, v22, v23 quad_perm:[1,0,3,2] row_mask:0x2 bank_mask:0xf
    s_nop 1
    v_add_f32_dpp v32, v13, v12 quad_perm:[1,0,3,2] row_mask:0x4 bank_mask:0xf
    v_add_f32_dpp v33, v14, v15 quad_perm:[1,0,3,2] row_mask:0x4 bank_mask:0xf
    s_nop 1
    v_add_f32_dpp v32, v17, v16 quad_perm:[1,0,3,2] row_mask:0x8 bank_mask:0xf
    v_add_f32_dpp v33, v18, v19 quad_perm:[1,0,3,2] row_mask:0x8 bank_mask:0xf
    v_cndmask_b32 v31, v32, v33, s[24:25]
    v_max3_f32 v46, v46, v30, v31
    s_cmp_ge_u32 s82, 16
    s_cbranch_scc1 Lki_40
    s_call_b64 s[80:81], SUB_LN
Lki_40:
    v_max_f32_dpp v46, v46, v46 quad_perm:[2,3,0,1] row_mask:0xf bank_mask:0xf
    s_nop 1
    v_max_f32_dpp v46, v46, v46 row_ror:4 row_mask:0xf bank_mask:0xf
    s_nop 1
    v_max_f32_dpp v46, v46, v46 row_ror:8 row_mask:0xf bank_mask:0xf
    v_mov_b32 v32, v46
    s_nop 1
    v_permlane16_swap_b32 v46, v32
    v_max_f32 v46, v46, v32
    v_mov_b32 v32, v46
    s_nop 1
    v_permlane32_swap_b32 v46, v32
    v_max_f32 v46, v46, v32
    v_mul_f32 v32, s26, v46
    v_fma_f32 v24, v24, s26, -v32
    v_fma_f32 v25, v25, s26, -v32
    v_fma_f32 v26, v26, s26, -v32
    v_fma_f32 v27, v27, s26, -v32
    v_fma_f32 v28, v28, s26, -v32
    v_fma_f32 v29, v29, s26, -v32
    v_fma_f32 v30, v30, s26, -v32
    v_fma_f32 v31, v31, s26, -v32
    v_exp_f32 v24, v24
    v_exp_f32 v25, v25
    v_exp_f32 v26, v26
    v_exp_f32 v27, v27
    v_exp_f32 v28, v28
    v_exp_f32 v29, v29
    v_exp_f32 v30, v30
    v_exp_f32 v31, v31
    v_pk_add_f32 v[4:5], v[24:25], v[26:27]
    v_pk_add_f32 v[6:7], v[28:29], v[30:31]
    v_pk_add_f32 v[4:5], v[4:5], v[6:7]
    v_add_f32 v20, v4, v5
    v_mov_b32_dpp v21, v24 quad_perm:[1,0,3,2] row_mask:0xf bank_mask:0xf
    v_cvt_pk_bf16_f32 v24, v24, v21
    v_mov_b32_dpp v22, v25 quad_perm:[1,0,3,2] row_mask:0xf bank_mask:0xf
    v_add_f32_dpp v20, v20, v20 quad_perm:[2,3,0,1] row_mask:0xf bank_mask:0xf
    v_cvt_pk_bf16_f32 v25, v25, v22
    v_mov_b32_dpp v21, v26 quad_perm:[1,0,3,2] row_mask:0xf bank_mask:0xf
    v_cvt_pk_bf16_f32 v26, v26, v21
    v_mov_b32_dpp v22, v27 quad_perm:[1,0,3,2] row_mask:0xf bank_mask:0xf
    v_add_f32_dpp v20, v20, v20 row_ror:8 row_mask:0xf bank_mask:0xf
    v_cvt_pk_bf16_f32 v27, v27, v22
    v_mov_b32_dpp v21, v28 quad_perm:[1,0,3,2] row_mask:0xf bank_mask:0xf
    v_cvt_pk_bf16_f32 v28, v28, v21
    v_mov_b32_dpp v22, v29 quad_perm:[1,0,3,2] row_mask:0xf bank_mask:0xf
    v_add_f32_dpp v20, v20, v20 row_ror:4 row_mask:0xf bank_mask:0xf
    v_cvt_pk_bf16_f32 v29, v29, v22
    v_mov_b32_dpp v21, v30 quad_perm:[1,0,3,2] row_mask:0xf bank_mask:0xf
    v_cvt_pk_bf16_f32 v30, v30, v21
    v_mov_b32_dpp v22, v31 quad_perm:[1,0,3,2] row_mask:0xf bank_mask:0xf
    v_cvt_pk_bf16_f32 v31, v31, v22
    v_mov_b32 v21, v20
    s_nop 1
    v_permlane16_swap_b32 v20, v21
    v_add_f32 v20, v20, v21
    v_mov_b32 v21, v20
    s_nop 1
    v_permlane32_swap_b32 v20, v21
    v_add_f32 v20, v20, v21
    v_and_b32 v32, 3, v0
    v_mul_u32_u24 v32, 0x5555, v32
    v_add_u32 v33, s29, v2
    s_cmp_gt_u32 s82, 10
    s_cbranch_scc1 Lsk_41
    s_call_b64 s[80:81], SUB_LN
Lsk_41:
    s_waitcnt vmcnt(20)
    ds_read_b128 v[4:7], v33 offset:0
    ds_read_b128 v[8:11], v33 offset:1024
    s_waitcnt vmcnt(16)
    ds_read_b128 v[12:15], v33 offset:2048
    ds_read_b128 v[16:19], v33 offset:3072
    v_and_b32_dpp v34, v24, v3 row_newbcast:0 row_mask:0xf bank_mask:0x3
    v_and_b32_dpp v35, v24, v3 row_newbcast:0 row_mask:0xf bank_mask:0xc
    v_and_b32_dpp v36, v24, v3 row_newbcast:2 row_mask:0xf bank_mask:0x3
    v_and_b32_dpp v37, v24, v3 row_newbcast:2 row_mask:0xf bank_mask:0xc
    v_and_b32_dpp v38, v24, v3 row_newbcast:4 row_mask:0xf bank_mask:0x3
    v_and_b32_dpp v39, v24, v3 row_newbcast:4 row_mask:0xf bank_mask:0xc
    v_and_b32_dpp v40, v24, v3 row_newbcast:6 row_mask:0xf bank_mask:0x3
    v_and_b32_dpp v41, v24, v3 row_newbcast:6 row_mask:0xf bank_mask:0xc
    s_waitcnt lgkmcnt(2)
    v_smfmac_f32_16x16x64_bf16 v[42:45], v[34:37], v[4:11], v32
    s_cmp_gt_u32 s82, 11
    s_cbranch_scc1 Lsk_42
    s_call_b64 s[80:81], SUB_LN
Lsk_42:
    s_waitcnt vmcnt(20)
    ds_read_b128 v[4:7], v33 offset:4096
    ds_read_b128 v[8:11], v33 offset:5120
    v_and_b32_dpp v34, v24, v3 row_newbcast:8 row_mask:0xf bank_mask:0x3
    v_and_b32_dpp v35, v24, v3 row_newbcast:8 row_mask:0xf bank_mask:0xc
    v_and_b32_dpp v36, v24, v3 row_newbcast:10 row_mask:0xf bank_mask:0x3
    v_and_b32_dpp v37, v24, v3 row_newbcast:10 row_mask:0xf bank_mask:0xc
    v_smfmac_f32_16x16x64_bf16 v[42:45], v[38:41], v[56:63], v32
    v_and_b32_dpp v38, v24, v3 row_newbcast:12 row_mask:0xf bank_mask:0x3
    v_and_b32_dpp v39, v24, v3 row_newbcast:12 row_mask:0xf bank_mask:0xc
    v_and_b32_dpp v40, v24, v3 row_newbcast:14 row_mask:0xf bank_mask:0x3
    v_and_b32_dpp v41, v24, v3 row_newbcast:14 row_mask:0xf bank_mask:0xc
    s_waitcnt lgkmcnt(2)
    v_smfmac_f32_16x16x64_bf16 v[42:45], v[34:37], v[12:19], v32
    s_waitcnt vmcnt(16)
    ds_read_b128 v[12:15], v33 offset:6144
    ds_read_b128 v[16:19], v33 offset:7168
    v_and_b32_dpp v34, v25, v3 row_newbcast:0 row_mask:0xf bank_mask:0x3
    v_and_b32_dpp v35, v25, v3 row_newbcast:0 row_mask:0xf bank_mask:0xc
    v_and_b32_dpp v36, v25, v3 row_newbcast:2 row_mask:0xf bank_mask:0x3
    v_and_b32_dpp v37, v25, v3 row_newbcast:2 row_mask:0xf bank_mask:0xc
    v_smfmac_f32_16x16x64_bf16 v[42:45], v[38:41], v[64:71], v32
    v_and_b32_dpp v38, v25, v3 row_newbcast:4 row_mask:0xf bank_mask:0x3
    v_and_b32_dpp v39, v25, v3 row_newbcast:4 row_mask:0xf bank_mask:0xc
    v_and_b32_dpp v40, v25, v3 row_newbcast:6 row_mask:0xf bank_mask:0x3
    v_and_b32_dpp v41, v25, v3 row_newbcast:6 row_mask:0xf bank_mask:0xc
    s_waitcnt lgkmcnt(2)
    v_smfmac_f32_16x16x64_bf16 v[42:45], v[34:37], v[4:11], v32
    s_cmp_gt_u32 s82, 12
    s_cbranch_scc1 Lsk_43
    s_call_b64 s[80:81], SUB_LN
Lsk_43:
    s_waitcnt vmcnt(20)
    ds_read_b128 v[4:7], v33 offset:8192
    ds_read_b128 v[8:11], v33 offset:9216
    v_and_b32_dpp v34, v25, v3 row_newbcast:8 row_mask:0xf bank_mask:0x3
    v_and_b32_dpp v35, v25, v3 row_newbcast:8 row_mask:0xf bank_mask:0xc
    v_and_b32_dpp v36, v25, v3 row_newbcast:10 row_mask:0xf bank_mask:0x3
    v_and_b32_dpp v37, v25, v3 row_newbcast:10 row_mask:0xf bank_mask:0xc
    v_smfmac_f32_16x16x64_bf16 v[42:45], v[38:41], v[72:79], v32
    v_and_b32_dpp v38, v25, v3 row_newbcast:12 row_mask:0xf bank_mask:0x3
    v_and_b32_dpp v39, v25, v3 row_newbcast:12 row_mask:0xf bank_mask:0xc
    v_and_b32_dpp v40, v25, v3 row_newbcast:14 row_mask:0xf bank_mask:0x3
    v_and_b32_dpp v41, v25, v3 row_newbcast:14 row_mask:0xf bank_mask:0xc
    s_waitcnt lgkmcnt(2)
    v_smfmac_f32_16x16x64_bf16 v[42:45], v[34:37], v[12:19], v32
    s_waitcnt vmcnt(16)
    ds_read_b128 v[12:15], v33 offset:10240
    ds_read_b128 v[16:19], v33 offset:11264
    v_and_b32_dpp v34, v26, v3 row_newbcast:0 row_mask:0xf bank_mask:0x3
    v_and_b32_dpp v35, v26, v3 row_newbcast:0 row_mask:0xf bank_mask:0xc
    v_and_b32_dpp v36, v26, v3 row_newbcast:2 row_mask:0xf bank_mask:0x3
    v_and_b32_dpp v37, v26, v3 row_newbcast:2 row_mask:0xf bank_mask:0xc
    v_smfmac_f32_16x16x64_bf16 v[42:45], v[38:41], v[80:87], v32
    v_and_b32_dpp v38, v26, v3 row_newbcast:4 row_mask:0xf bank_mask:0x3
    v_and_b32_dpp v39, v26, v3 row_newbcast:4 row_mask:0xf bank_mask:0xc
    v_and_b32_dpp v40, v26, v3 row_newbcast:6 row_mask:0xf bank_mask:0x3
    v_and_b32_dpp v41, v26, v3 row_newbcast:6 row_mask:0xf bank_mask:0xc
    s_waitcnt lgkmcnt(2)
    v_smfmac_f32_16x16x64_bf16 v[42:45], v[34:37], v[4:11], v32
    s_cmp_gt_u32 s82, 13
    s_cbranch_scc1 Lsk_44
    s_call_b64 s[80:81], SUB_LN
Lsk_44:
    s_waitcnt vmcnt(20)
    ds_read_b128 v[48:51], v33 offset:12288
    v_and_b32_dpp v34, v26, v3 row_newbcast:8 row_mask:0xf bank_mask:0x3
    v_and_b32_dpp v35, v26, v3 row_newbcast:8 row_mask:0xf bank_mask:0xc
    v_and_b32_dpp v36, v26, v3 row_newbcast:10 row_mask:0xf bank_mask:0x3
    v_and_b32_dpp v37, v26, v3 row_newbcast:10 row_mask:0xf bank_mask:0xc
    v_smfmac_f32_16x16x64_bf16 v[42:45], v[38:41], v[88:95], v32
    v_and_b32_dpp v38, v26, v3 row_newbcast:12 row_mask:0xf bank_mask:0x3
    v_and_b32_dpp v39, v26, v3 row_newbcast:12 row_mask:0xf bank_mask:0xc
    v_and_b32_dpp v40, v26, v3 row_newbcast:14 row_mask:0xf bank_mask:0x3
    v_and_b32_dpp v41, v26, v3 row_newbcast:14 row_mask:0xf bank_mask:0xc
    s_waitcnt lgkmcnt(1)
    v_smfmac_f32_16x16x64_bf16 v[42:45], v[34:37], v[12:19], v32
    v_and_b32_dpp v34, v27, v3 row_newbcast:0 row_mask:0xf bank_mask:0x3
    v_and_b32_dpp v35, v27, v3 row_newbcast:0 row_mask:0xf bank_mask:0xc
    v_and_b32_dpp v36, v27, v3 row_newbcast:2 row_mask:0xf bank_mask:0x3
    v_and_b32_dpp v37, v27, v3 row_newbcast:2 row_mask:0xf bank_mask:0xc
    v_smfmac_f32_16x16x64_bf16 v[42:45], v[38:41], v[96:103], v32
    v_and_b32_dpp v38, v27, v3 row_newbcast:4 row_mask:0xf bank_mask:0x3
    v_and_b32_dpp v39, v27, v3 row_newbcast:4 row_mask:0xf bank_mask:0xc
    v_and_b32_dpp v40, v27, v3 row_newbcast:6 row_mask:0xf bank_mask:0x3
    v_and_b32_dpp v41, v27, v3 row_newbcast:6 row_mask:0xf bank_mask:0xc
    s_waitcnt lgkmcnt(0)
    v_smfmac_f32_16x16x64_bf16 v[42:45], v[34:37], v[48:55], v32
    v_and_b32_dpp v34, v27, v3 row_newbcast:8 row_mask:0xf bank_mask:0x3
    v_and_b32_dpp v35, v27, v3 row_newbcast:8 row_mask:0xf bank_mask:0xc
    v_and_b32_dpp v36, v27, v3 row_newbcast:10 row_mask:0xf bank_mask:0x3
    v_and_b32_dpp v37, v27, v3 row_newbcast:10 row_mask:0xf bank_mask:0xc
    v_smfmac_f32_16x16x64_bf16 v[42:45], v[38:41], v[104:111], v32
    v_and_b32_dpp v38, v27, v3 row_newbcast:12 row_mask:0xf bank_mask:0x3
    v_and_b32_dpp v39, v27, v3 row_newbcast:12 row_mask:0xf bank_mask:0xc
    v_and_b32_dpp v40, v27, v3 row_newbcast:14 row_mask:0xf bank_mask:0x3
    v_and_b32_dpp v41, v27, v3 row_newbcast:14 row_mask:0xf bank_mask:0xc
    s_waitcnt vmcnt(16)
    v_smfmac_f32_16x16x64_bf16 v[42:45], v[34:37], v[112:119], v32
    v_and_b32_dpp v34, v28, v3 row_newbcast:0 row_mask:0xf bank_mask:0x3
    v_and_b32_dpp v35, v28, v3 row_newbcast:0 row_mask:0xf bank_mask:0xc
    v_and_b32_dpp v36, v28, v3 row_newbcast:2 row_mask:0xf bank_mask:0x3
    v_and_b32_dpp v37, v28, v3 row_newbcast:2 row_mask:0xf bank_mask:0xc
    v_smfmac_f32_16x16x64_bf16 v[42:45], v[38:41], v[120:127], v32
    v_and_b32_dpp v38, v28, v3 row_newbcast:4 row_mask:0xf bank_mask:0x3
    v_and_b32_dpp v39, v28, v3 row_newbcast:4 row_mask:0xf bank_mask:0xc
    v_and_b32_dpp v40, v28, v3 row_newbcast:6 row_mask:0xf bank_mask:0x3
    v_and_b32_dpp v41, v28, v3 row_newbcast:6 row_mask:0xf bank_mask:0xc
    s_cmp_gt_u32 s82, 14
    s_cbranch_scc1 Lsk_45
    s_call_b64 s[80:81], SUB_LN
Lsk_45:
    s_waitcnt vmcnt(20)
    s_cmp_lg_u32 s63, 4
    s_cbranch_scc1 Lsg_46
    s_mov_b64 exec, 1
    buffer_atomic_add v3, v2, s[16:19], s60 offen sc1
    s_mov_b64 exec, -1
Lsg_46:
    v_smfmac_f32_16x16x64_bf16 v[42:45], v[34:37], v[128:135], v32
    v_and_b32_dpp v34, v28, v3 row_newbcast:8 row_mask:0xf bank_mask:0x3
    v_and_b32_dpp v35, v28, v3 row_newbcast:8 row_mask:0xf bank_mask:0xc
    v_and_b32_dpp v36, v28, v3 row_newbcast:10 row_mask:0xf bank_mask:0x3
    v_and_b32_dpp v37, v28, v3 row_newbcast:10 row_mask:0xf bank_mask:0xc
    v_smfmac_f32_16x16x64_bf16 v[42:45], v[38:41], v[136:143], v32
    v_and_b32_dpp v38, v28, v3 row_newbcast:12 row_mask:0xf bank_mask:0x3
    v_and_b32_dpp v39, v28, v3 row_newbcast:12 row_mask:0xf bank_mask:0xc
    v_and_b32_dpp v40, v28, v3 row_newbcast:14 row_mask:0xf bank_mask:0x3
    v_and_b32_dpp v41, v28, v3 row_newbcast:14 row_mask:0xf bank_mask:0xc
    s_waitcnt vmcnt(16)
    v_smfmac_f32_16x16x64_bf16 v[42:45], v[34:37], v[144:151], v32
    v_and_b32_dpp v34, v29, v3 row_newbcast:0 row_mask:0xf bank_mask:0x3
    v_and_b32_dpp v35, v29, v3 row_newbcast:0 row_mask:0xf bank_mask:0xc
    v_and_b32_dpp v36, v29, v3 row_newbcast:2 row_mask:0xf bank_mask:0x3
    v_and_b32_dpp v37, v29, v3 row_newbcast:2 row_mask:0xf bank_mask:0xc
    v_smfmac_f32_16x16x64_bf16 v[42:45], v[38:41], v[152:159], v32
L_att_resume:
    v_and_b32_dpp v38, v29, v3 row_newbcast:4 row_mask:0xf bank_mask:0x3
    v_and_b32_dpp v39, v29, v3 row_newbcast:4 row_mask:0xf bank_mask:0xc
    v_and_b32_dpp v40, v29, v3 row_newbcast:6 row_mask:0xf bank_mask:0x3
    v_and_b32_dpp v41, v29, v3 row_newbcast:6 row_mask:0xf bank_mask:0xc
    s_cmp_gt_u32 s82, 15
    s_cbranch_scc1 Lsk_47
    s_call_b64 s[80:81], SUB_LN
Lsk_47:
    s_waitcnt vmcnt(20)
    v_smfmac_f32_16x16x64_bf16 v[42:45], v[34:37], v[160:167], v32
    v_and_b32_dpp v34, v29, v3 row_newbcast:8 row_mask:0xf bank_mask:0x3
    v_and_b32_dpp v35, v29, v3 row_newbcast:8 row_mask:0xf bank_mask:0xc
    v_and_b32_dpp v36, v29, v3 row_newbcast:10 row_mask:0xf bank_mask:0x3
    v_and_b32_dpp v37, v29, v3 row_newbcast:10 row_mask:0xf bank_mask:0xc
    v_smfmac_f32_16x16x64_bf16 v[42:45], v[38:41], v[168:175], v32
    v_and_b32_dpp v38, v29, v3 row_newbcast:12 row_mask:0xf bank_mask:0x3
    v_and_b32_dpp v39, v29, v3 row_newbcast:12 row_mask:0xf bank_mask:0xc
    v_and_b32_dpp v40, v29, v3 row_newbcast:14 row_mask:0xf bank_mask:0x3
    v_and_b32_dpp v41, v29, v3 row_newbcast:14 row_mask:0xf bank_mask:0xc
    s_waitcnt vmcnt(16)
    v_smfmac_f32_16x16x64_bf16 v[42:45], v[34:37], v[176:183], v32
    v_and_b32_dpp v34, v30, v3 row_newbcast:0 row_mask:0xf bank_mask:0x3
    v_and_b32_dpp v35, v30, v3 row_newbcast:0 row_mask:0xf bank_mask:0xc
    v_and_b32_dpp v36, v30, v3 row_newbcast:2 row_mask:0xf bank_mask:0x3
    v_and_b32_dpp v37, v30, v3 row_newbcast:2 row_mask:0xf bank_mask:0xc
    v_smfmac_f32_16x16x64_bf16 v[42:45], v[38:41], v[184:191], v32
    v_and_b32_dpp v38, v30, v3 row_newbcast:4 row_mask:0xf bank_mask:0x3
    v_and_b32_dpp v39, v30, v3 row_newbcast:4 row_mask:0xf bank_mask:0xc
    v_and_b32_dpp v40, v30, v3 row_newbcast:6 row_mask:0xf bank_mask:0x3
    v_and_b32_dpp v41, v30, v3 row_newbcast:6 row_mask:0xf bank_mask:0xc
    s_waitcnt vmcnt(12)
    v_smfmac_f32_16x16x64_bf16 v[42:45], v[34:37], v[192:199], v32
    v_and_b32_dpp v34, v30, v3 row_newbcast:8 row_mask:0xf bank_mask:0x3
    v_and_b32_dpp v35, v30, v3 row_newbcast:8 row_mask:0xf bank_mask:0xc
    v_and_b32_dpp v36, v30, v3 row_newbcast:10 row_mask:0xf bank_mask:0x3
    v_and_b32_dpp v37, v30, v3 row_newbcast:10 row_mask:0xf bank_mask:0xc
    v_smfmac_f32_16x16x64_bf16 v[42:45], v[38:41], v[200:207], v32
    v_and_b32_dpp v38, v30, v3 row_newbcast:12 row_mask:0xf bank_mask:0x3
    v_and_b32_dpp v39, v30, v3 row_newbcast:12 row_mask:0xf bank_mask:0xc
    v_and_b32_dpp v40, v30, v3 row_newbcast:14 row_mask:0xf bank_mask:0x3
    v_and_b32_dpp v41, v30, v3 row_newbcast:14 row_mask:0xf bank_mask:0xc
    s_waitcnt vmcnt(8)
    v_smfmac_f32_16x16x64_bf16 v[42:45], v[34:37], v[208:215], v32
    v_and_b32_dpp v34, v31, v3 row_newbcast:0 row_mask:0xf bank_mask:0x3
    v_and_b32_dpp v35, v31, v3 row_newbcast:0 row_mask:0xf bank_mask:0xc
    v_and_b32_dpp v36, v31, v3 row_newbcast:2 row_mask:0xf bank_mask:0x3
    v_and_b32_dpp v37, v31, v3 row_newbcast:2 row_mask:0xf bank_mask:0xc
    v_smfmac_f32_16x16x64_bf16 v[42:45], v[38:41], v[216:223], v32
    v_and_b32_dpp v38, v31, v3 row_newbcast:4 row_mask:0xf bank_mask:0x3
    v_and_b32_dpp v39, v31, v3 row_newbcast:4 row_mask:0xf bank_mask:0xc
    v_and_b32_dpp v40, v31, v3 row_newbcast:6 row_mask:0xf bank_mask:0x3
    v_and_b32_dpp v41, v31, v3 row_newbcast:6 row_mask:0xf bank_mask:0xc
    s_waitcnt vmcnt(4)
    v_smfmac_f32_16x16x64_bf16 v[42:45], v[34:37], v[224:231], v32
    v_and_b32_dpp v34, v31, v3 row_newbcast:8 row_mask:0xf bank_mask:0x3
    v_and_b32_dpp v35, v31, v3 row_newbcast:8 row_mask:0xf bank_mask:0xc
    v_and_b32_dpp v36, v31, v3 row_newbcast:10 row_mask:0xf bank_mask:0x3
    v_and_b32_dpp v37, v31, v3 row_newbcast:10 row_mask:0xf bank_mask:0xc
    v_smfmac_f32_16x16x64_bf16 v[42:45], v[38:41], v[232:239], v32
    v_and_b32_dpp v38, v31, v3 row_newbcast:12 row_mask:0xf bank_mask:0x3
    v_and_b32_dpp v39, v31, v3 row_newbcast:12 row_mask:0xf bank_mask:0xc
    v_and_b32_dpp v40, v31, v3 row_newbcast:14 row_mask:0xf bank_mask:0x3
    v_and_b32_dpp v41, v31, v3 row_newbcast:14 row_mask:0xf bank_mask:0xc
    s_waitcnt vmcnt(2)
    v_smfmac_f32_16x16x64_bf16 v[42:45], v[34:37], v[240:247], v32
    s_waitcnt vmcnt(0)
    v_smfmac_f32_16x16x64_bf16 v[42:45], v[38:41], v[248:255], v32
    s_branch L_att_epi
SUB_QATT:
    v_bfe_u32 v15, v0, 1, 1
    v_lshlrev_b32 v12, 8, v15
    v_lshrrev_b32 v13, 4, v0
    v_lshl_add_u32 v12, v13, 5, v12
    v_and_b32 v14, 1, v0
    v_lshl_add_u32 v12, v14, 4, v12
    v_add_u32 v12, s65, v12
    v_bfe_u32 v15, v0, 4, 1
    v_lshlrev_b32 v47, 9, v15
    v_and_b32 v15, 15, v0
    v_lshl_add_u32 v47, v15, 5, v47
    v_lshrrev_b32 v15, 5, v0
    v_lshl_add_u32 v47, v15, 4, v47
    s_lshl_b32 s70, s3, 10
    s_add_u32 s70, s70, s64
    v_add_u32 v47, s70, v47
    v_bfe_u32 v32, v0, 1, 1
    v_lshlrev_b32 v32, 8, v32
    v_lshl_add_u32 v32, v13, 6, v32
    v_lshl_add_u32 v32, v14, 4, v32
    v_and_b32 v15, 4, v0
    v_add3_u32 v32, v32, v15, s65
    v_mul_u32_u24 v33, 0x2aaa, v15
    v_add_u32 v33, 0x4444, v33
    v_lshrrev_b32 v15, 1, v15
    v_add_u32 v33, v33, v15
    s_lshl_b32 s70, s3, 8
    v_lshl_add_u32 v22, v0, 2, s70
    s_mul_i32 s70, s4, 9216
    s_add_u32 s70, s70, s62
    s_add_u32 s71, s70, 4096
    s_add_u32 s72, s70, 8192
    v_lshrrev_b32 v21, 1, v22
    v_add_u32 v21, s65, v21
    s_mov_b32 s74, 0x00ff00ff
    s_mov_b32 s75, 0x00ff00ff
    s_cmp_eq_u32 s69, 0
    s_cbranch_scc1 L_qatt_ns
    s_sleep 8
L_qatt_ns:
    s_mov_b32 s68, 0
Lpoll_48:
    buffer_load_dword v24, v22, s[16:19], s70 offen offset:0 sc1
    buffer_load_dword v25, v22, s[16:19], s70 offen offset:1024 sc1
    buffer_load_dword v26, v22, s[16:19], s70 offen offset:2048 sc1
    buffer_load_dword v27, v22, s[16:19], s70 offen offset:3072 sc1
    buffer_load_dword v28, v22, s[16:19], s71 offen offset:0 sc1
    buffer_load_dword v29, v22, s[16:19], s71 offen offset:1024 sc1
    buffer_load_dword v30, v22, s[16:19], s71 offen offset:2048 sc1
    buffer_load_dword v31, v22, s[16:19], s71 offen offset:3072 sc1
    buffer_load_dword v46, v22, s[16:19], s72 offen offset:0 sc1
    v_mov_b32 v4, 0
    v_mov_b32 v5, 0
    v_mov_b32 v6, 0
    v_mov_b32 v7, 0
    v_mov_b32 v8, 0
    v_mov_b32 v9, 0
    v_mov_b32 v10, 0
    v_mov_b32 v11, 0
    v_mov_b32 v12, 0
    v_mov_b32 v13, 0
    v_mov_b32 v14, 0
    v_mov_b32 v15, 0
    v_mov_b32 v16, 0
    v_mov_b32 v17, 0
    v_mov_b32 v18, 0
    v_mov_b32 v19, 0
    v_mov_b32 v20, 0
    v_mov_b32 v48, 0
    v_mov_b32 v49, 0
    v_mov_b32 v50, 0
    v_mov_b32 v51, 0
    v_mov_b32 v34, 0
    v_mov_b32 v35, 0
    v_mov_b32 v36, 0
    v_mov_b32 v37, 0
    v_mov_b32 v38, 0
    v_mov_b32 v39, 0
    v_mov_b32 v40, 0
    v_mov_b32 v41, 0
    v_mov_b32 v42, 0
    v_mov_b32 v43, 0
    v_mov_b32 v44, 0
    v_mov_b32 v45, 0
    s_cmp_lt_u32 s82, 16
    s_cbranch_scc1 Lt_51
    s_waitcnt vmcnt(0)
Ltb_52:
    v_max3_u32 v23, v24, v25, v26
    v_max3_u32 v23, v23, v27, v28
    v_max3_u32 v23, v23, v29, v30
    v_max3_u32 v23, v23, v31, v46
    v_cmp_eq_u32 vcc, -1, v23
    s_cbranch_vccnz Lpr_50
Lpd_49:
    v_add_f32 v24, v24, v25
    v_add_f32 v26, v26, v27
    v_add_f32 v28, v28, v29
    v_add_f32 v30, v30, v31
    v_add_f32 v24, v24, v26
    v_add_f32 v28, v28, v30
    v_add_f32 v24, v24, v46
    v_add_f32 v24, v24, v28
    v_cvt_pk_bf16_f32 v24, v24, v24
    ds_write_b16 v21, v24
    v_mov_b32 v21, 0
    v_mov_b32 v22, 0
    v_mov_b32 v23, 0
    s_cmp_eq_u32 s63, 2
    s_cselect_b32 s82, 0, s82
    s_cselect_b64 vcc, -1, 0
    s_mov_b64 exec, s[74:75]
    s_waitcnt lgkmcnt(0)
    s_barrier
    ds_read2_b32 v[4:5], v32 offset0:0 offset1:2
    ds_read2_b32 v[6:7], v32 offset0:8 offset1:10
    s_not_b64 exec, exec
    ds_read2_b32 v[8:9], v32 offset0:0 offset1:2
    ds_read2_b32 v[10:11], v32 offset0:8 offset1:10
    s_mov_b64 exec, -1
    s_waitcnt lgkmcnt(0)
    v_smfmac_f32_16x16x64_bf16 v[12:15], v[4:7], a[0:7], v33
    v_smfmac_f32_16x16x64_bf16 v[16:19], v[4:7], a[8:15], v33
    v_smfmac_f32_16x16x64_bf16 v[12:15], v[8:11], a[16:23], v33
    v_smfmac_f32_16x16x64_bf16 v[16:19], v[8:11], a[24:31], v33
    s_cbranch_vccnz Lo_53
Lb_54:
    v_smfmac_f32_16x16x64_bf16 v[20:23], v[4:7], a[32:39], v33
    v_smfmac_f32_16x16x64_bf16 v[48:51], v[4:7], a[40:47], v33
    s_nop 3
    v_add_f32_dpp v32, v13, v12 quad_perm:[1,0,3,2] row_mask:0xf bank_mask:0xf
    v_add_f32_dpp v46, v14, v15 quad_perm:[1,0,3,2] row_mask:0xf bank_mask:0xf
    v_smfmac_f32_16x16x64_bf16 v[20:23], v[8:11], a[48:55], v33
    v_cndmask_b32 v24, v32, v46, s[24:25]
    v_add_f32_dpp v32, v17, v16 quad_perm:[1,0,3,2] row_mask:0xf bank_mask:0xf
    v_add_f32_dpp v46, v18, v19 quad_perm:[1,0,3,2] row_mask:0xf bank_mask:0xf
    v_smfmac_f32_16x16x64_bf16 v[48:51], v[8:11], a[56:63], v33
    v_cndmask_b32 v32, v32, v46, s[24:25]
    s_cbranch_vccnz Lo_55
Lb_56:
    v_smfmac_f32_16x16x64_bf16 v[12:15], v[4:7], a[64:71], v33
    v_smfmac_f32_16x16x64_bf16 v[16:19], v[4:7], a[72:79], v33
    v_permlane16_swap_b32 v24, v32
    v_add_f32 v24, v24, v32
    v_add_f32_dpp v32, v21, v20 quad_perm:[1,0,3,2] row_mask:0xf bank_mask:0xf
    v_add_f32_dpp v46, v22, v23 quad_perm:[1,0,3,2] row_mask:0xf bank_mask:0xf
    v_smfmac_f32_16x16x64_bf16 v[12:15], v[8:11], a[80:87], v33
    v_cndmask_b32 v25, v32, v46, s[24:25]
    v_add_f32_dpp v32, v49, v48 quad_perm:[1,0,3,2] row_mask:0xf bank_mask:0xf
    v_add_f32_dpp v46, v50, v51 quad_perm:[1,0,3,2] row_mask:0xf bank_mask:0xf
    v_smfmac_f32_16x16x64_bf16 v[16:19], v[8:11], a[88:95], v33
    v_cndmask_b32 v32, v32, v46, s[24:25]
    v_smfmac_f32_16x16x64_bf16 v[20:23], v[4:7], a[96:103], v33
    v_smfmac_f32_16x16x64_bf16 v[48:51], v[4:7], a[104:111], v33
    v_permlane16_swap_b32 v25, v32
    v_add_f32 v25, v25, v32
    v_add_f32_dpp v32, v13, v12 quad_perm:[1,0,3,2] row_mask:0xf bank_mask:0xf
    v_add_f32_dpp v46, v14, v15 quad_perm:[1,0,3,2] row_mask:0xf bank_mask:0xf
    v_smfmac_f32_16x16x64_bf16 v[20:23], v[8:11], a[112:119], v33
    v_cndmask_b32 v26, v32, v46, s[24:25]
    v_add_f32_dpp v32, v17, v16 quad_perm:[1,0,3,2] row_mask:0xf bank_mask:0xf
    v_add_f32_dpp v46, v18, v19 quad_perm:[1,0,3,2] row_mask:0xf bank_mask:0xf
    v_smfmac_f32_16x16x64_bf16 v[48:51], v[8:11], a[120:127], v33
    v_cndmask_b32 v32, v32, v46, s[24:25]
    v_smfmac_f32_16x16x64_bf16 v[12:15], v[4:7], a[128:135], v33
    v_smfmac_f32_16x16x64_bf16 v[16:19], v[4:7], a[136:143], v33
    v_permlane16_swap_b32 v26, v32
    v_add_f32 v26, v26, v32
    v_add_f32_dpp v32, v21, v20 quad_perm:[1,0,3,2] row_mask:0xf bank_mask:0xf
    v_add_f32_dpp v46, v22, v23 quad_perm:[1,0,3,2] row_mask:0xf bank_mask:0xf
    v_smfmac_f32_16x16x64_bf16 v[12:15], v[8:11], a[144:151], v33
    v_cndmask_b32 v27, v32, v46, s[24:25]
    v_add_f32_dpp v32, v49, v48 quad_perm:[1,0,3,2] row_mask:0xf bank_mask:0xf
    v_add_f32_dpp v46, v50, v51 quad_perm:[1,0,3,2] row_mask:0xf bank_mask:0xf
    v_smfmac_f32_16x16x64_bf16 v[16:19], v[8:11], a[152:159], v33
    v_cndmask_b32 v32, v32, v46, s[24:25]
    v_smfmac_f32_16x16x64_bf16 v[20:23], v[4:7], a[160:167], v33
    v_smfmac_f32_16x16x64_bf16 v[48:51], v[4:7], a[168:175], v33
    v_permlane16_swap_b32 v27, v32
    v_add_f32 v27, v27, v32
    v_add_f32_dpp v32, v13, v12 quad_perm:[1,0,3,2] row_mask:0xf bank_mask:0xf
    v_add_f32_dpp v46, v14, v15 quad_perm:[1,0,3,2] row_mask:0xf bank_mask:0xf
    v_smfmac_f32_16x16x64_bf16 v[20:23], v[8:11], a[176:183], v33
    v_cndmask_b32 v28, v32, v46, s[24:25]
    v_add_f32_dpp v32, v17, v16 quad_perm:[1,0,3,2] row_mask:0xf bank_mask:0xf
    v_add_f32_dpp v46, v18, v19 quad_perm:[1,0,3,2] row_mask:0xf bank_mask:0xf
    v_smfmac_f32_16x16x64_bf16 v[48:51], v[8:11], a[184:191], v33
    v_cndmask_b32 v32, v32, v46, s[24:25]
    v_smfmac_f32_16x16x64_bf16 v[12:15], v[4:7], a[192:199], v33
    v_smfmac_f32_16x16x64_bf16 v[16:19], v[4:7], a[200:207], v33
    v_permlane16_swap_b32 v28, v32
    v_add_f32 v28, v28, v32
    v_add_f32_dpp v32, v21, v20 quad_perm:[1,0,3,2] row_mask:0xf bank_mask:0xf
    v_add_f32_dpp v46, v22, v23 quad_perm:[1,0,3,2] row_mask:0xf bank_mask:0xf
    v_smfmac_f32_16x16x64_bf16 v[12:15], v[8:11], a[208:215], v33
    v_cndmask_b32 v29, v32, v46, s[24:25]
    v_add_f32_dpp v32, v49, v48 quad_perm:[1,0,3,2] row_mask:0xf bank_mask:0xf
    v_add_f32_dpp v46, v50, v51 quad_perm:[1,0,3,2] row_mask:0xf bank_mask:0xf
    v_smfmac_f32_16x16x64_bf16 v[16:19], v[8:11], a[216:223], v33
    v_cndmask_b32 v32, v32, v46, s[24:25]
    v_smfmac_f32_16x16x64_bf16 v[20:23], v[4:7], a[224:231], v33
    v_smfmac_f32_16x16x64_bf16 v[48:51], v[4:7], a[232:239], v33
    v_permlane16_swap_b32 v29, v32
    v_add_f32 v29, v29, v32
    v_add_f32_dpp v32, v13, v12 quad_perm:[1,0,3,2] row_mask:0xf bank_mask:0xf
    v_add_f32_dpp v46, v14, v15 quad_perm:[1,0,3,2] row_mask:0xf bank_mask:0xf
    v_smfmac_f32_16x16x64_bf16 v[20:23], v[8:11], a[240:247], v33
    v_cndmask_b32 v30, v32, v46, s[24:25]
    v_add_f32_dpp v32, v17, v16 quad_perm:[1,0,3,2] row_mask:0xf bank_mask:0xf
    v_add_f32_dpp v46, v18, v19 quad_perm:[1,0,3,2] row_mask:0xf bank_mask:0xf
    v_smfmac_f32_16x16x64_bf16 v[48:51], v[8:11], a[248:255], v33
    v_cndmask_b32 v32, v32, v46, s[24:25]
    s_nop 1
    v_permlane16_swap_b32 v30, v32
    v_add_f32 v30, v30, v32
    v_add_f32_dpp v32, v21, v20 quad_perm:[1,0,3,2] row_mask:0xf bank_mask:0xf
    v_add_f32_dpp v46, v22, v23 quad_perm:[1,0,3,2] row_mask:0xf bank_mask:0xf
    v_cndmask_b32 v31, v32, v46, s[24:25]
    v_add_f32_dpp v32, v49, v48 quad_perm:[1,0,3,2] row_mask:0xf bank_mask:0xf
    v_add_f32_dpp v46, v50, v51 quad_perm:[1,0,3,2] row_mask:0xf bank_mask:0xf
    v_cndmask_b32 v32, v32, v46, s[24:25]
    s_nop 1
    v_permlane16_swap_b32 v31, v32
    v_add_f32 v31, v31, v32
    v_pk_add_f32 v[30:31], v[30:31], v[28:29] neg_lo:[0,1] neg_hi:[0,1]
    v_pk_add_f32 v[28:29], v[28:29], v[26:27] neg_lo:[0,1] neg_hi:[0,1]
    v_pk_add_f32 v[26:27], v[26:27], v[24:25] neg_lo:[0,1] neg_hi:[0,1]
    v_max3_f32 v46, v24, v25, v30
    v_max3_f32 v32, v31, v28, v29
    v_max3_f32 v46, v46, v26, v27
    v_max_f32 v46, v46, v32
    s_nop 1
    v_max_f32_dpp v46, v46, v46 quad_perm:[2,3,0,1] row_mask:0xf bank_mask:0xf
    s_nop 1
    v_max_f32_dpp v46, v46, v46 row_ror:4 row_mask:0xf bank_mask:0xf
    s_nop 1
    v_max_f32_dpp v46, v46, v46 row_ror:8 row_mask:0xf bank_mask:0xf
    v_mov_b32 v32, v46
    s_nop 1
    v_permlane16_swap_b32 v46, v32
    v_max_f32 v46, v46, v32
    v_mov_b32 v32, v46
    s_nop 1
    v_permlane32_swap_b32 v46, v32
    v_max_f32 v46, v46, v32
    v_mul_f32 v32, s26, v46
    v_fma_f32 v24, v24, s26, -v32
    v_fma_f32 v25, v25, s26, -v32
    v_fma_f32 v26, v26, s26, -v32
    v_fma_f32 v27, v27, s26, -v32
    v_fma_f32 v28, v28, s26, -v32
    v_fma_f32 v29, v29, s26, -v32
    v_fma_f32 v30, v30, s26, -v32
    v_fma_f32 v31, v31, s26, -v32
    v_exp_f32 v24, v24
    v_exp_f32 v25, v25
    v_exp_f32 v26, v26
    v_exp_f32 v27, v27
    v_exp_f32 v28, v28
    v_exp_f32 v29, v29
    v_exp_f32 v30, v30
    v_exp_f32 v31, v31
    v_pk_add_f32 v[4:5], v[24:25], v[26:27]
    v_pk_add_f32 v[6:7], v[28:29], v[30:31]
    v_pk_add_f32 v[4:5], v[4:5], v[6:7]
    v_add_f32 v20, v4, v5
    v_mov_b32_dpp v21, v24 quad_perm:[1,0,3,2] row_mask:0xf bank_mask:0xf
    v_cvt_pk_bf16_f32 v24, v24, v21
    v_mov_b32_dpp v22, v25 quad_perm:[1,0,3,2] row_mask:0xf bank_mask:0xf
    v_add_f32_dpp v20, v20, v20 quad_perm:[2,3,0,1] row_mask:0xf bank_mask:0xf
    v_cvt_pk_bf16_f32 v25, v25, v22
    v_mov_b32_dpp v21, v26 quad_perm:[1,0,3,2] row_mask:0xf bank_mask:0xf
    v_cvt_pk_bf16_f32 v26, v26, v21
    v_mov_b32_dpp v22, v27 quad_perm:[1,0,3,2] row_mask:0xf bank_mask:0xf
    v_add_f32_dpp v20, v20, v20 row_ror:8 row_mask:0xf bank_mask:0xf
    v_cvt_pk_bf16_f32 v27, v27, v22
    v_mov_b32_dpp v21, v28 quad_perm:[1,0,3,2] row_mask:0xf bank_mask:0xf
    v_cvt_pk_bf16_f32 v28, v28, v21
    v_mov_b32_dpp v22, v29 quad_perm:[1,0,3,2] row_mask:0xf bank_mask:0xf
    v_add_f32_dpp v20, v20, v20 row_ror:4 row_mask:0xf bank_mask:0xf
    v_cvt_pk_bf16_f32 v29, v29, v22
    v_mov_b32_dpp v21, v30 quad_perm:[1,0,3,2] row_mask:0xf bank_mask:0xf
    v_cvt_pk_bf16_f32 v30, v30, v21
    v_mov_b32_dpp v22, v31 quad_perm:[1,0,3,2] row_mask:0xf bank_mask:0xf
    v_cvt_pk_bf16_f32 v31, v31, v22
    v_mov_b32 v21, v20
    s_nop 1
    v_permlane16_swap_b32 v20, v21
    v_add_f32 v20, v20, v21
    v_mov_b32 v21, v20
    s_nop 1
    v_permlane32_swap_b32 v20, v21
    v_add_f32 v20, v20, v21
    v_and_b32 v32, 3, v0
    v_mul_u32_u24 v32, 0x5555, v32
    v_add_u32 v33, s29, v2
    ds_read_b128 v[4:7], v33 offset:0
    ds_read_b128 v[8:11], v33 offset:1024
    ds_read_b128 v[12:15], v33 offset:2048
    ds_read_b128 v[16:19], v33 offset:3072
    v_and_b32_dpp v34, v24, v3 row_newbcast:0 row_mask:0xf bank_mask:0x3
    v_and_b32_dpp v35, v24, v3 row_newbcast:0 row_mask:0xf bank_mask:0xc
    v_and_b32_dpp v36, v24, v3 row_newbcast:2 row_mask:0xf bank_mask:0x3
    v_and_b32_dpp v37, v24, v3 row_newbcast:2 row_mask:0xf bank_mask:0xc
    v_and_b32_dpp v38, v24, v3 row_newbcast:4 row_mask:0xf bank_mask:0x3
    v_and_b32_dpp v39, v24, v3 row_newbcast:4 row_mask:0xf bank_mask:0xc
    v_and_b32_dpp v40, v24, v3 row_newbcast:6 row_mask:0xf bank_mask:0x3
    v_and_b32_dpp v41, v24, v3 row_newbcast:6 row_mask:0xf bank_mask:0xc
    s_waitcnt lgkmcnt(2)
    v_smfmac_f32_16x16x64_bf16 v[42:45], v[34:37], v[4:11], v32
    ds_read_b128 v[4:7], v33 offset:4096
    ds_read_b128 v[8:11], v33 offset:5120
    v_and_b32_dpp v34, v24, v3 row_newbcast:8 row_mask:0xf bank_mask:0x3
    v_and_b32_dpp v35, v24, v3 row_newbcast:8 row_mask:0xf bank_mask:0xc
    v_and_b32_dpp v36, v24, v3 row_newbcast:10 row_mask:0xf bank_mask:0x3
    v_and_b32_dpp v37, v24, v3 row_newbcast:10 row_mask:0xf bank_mask:0xc
    v_smfmac_f32_16x16x64_bf16 v[42:45], v[38:41], v[56:63], v32
    s_cbranch_vccnz Lo_57
Lb_58:
    v_and_b32_dpp v38, v24, v3 row_newbcast:12 row_mask:0xf bank_mask:0x3
    v_and_b32_dpp v39, v24, v3 row_newbcast:12 row_mask:0xf bank_mask:0xc
    v_and_b32_dpp v40, v24, v3 row_newbcast:14 row_mask:0xf bank_mask:0x3
    v_and_b32_dpp v41, v24, v3 row_newbcast:14 row_mask:0xf bank_mask:0xc
    s_waitcnt lgkmcnt(2)
    v_smfmac_f32_16x16x64_bf16 v[42:45], v[34:37], v[12:19], v32
    ds_read_b128 v[12:15], v33 offset:6144
    ds_read_b128 v[16:19], v33 offset:7168
    v_and_b32_dpp v34, v25, v3 row_newbcast:0 row_mask:0xf bank_mask:0x3
    v_and_b32_dpp v35, v25, v3 row_newbcast:0 row_mask:0xf bank_mask:0xc
    v_and_b32_dpp v36, v25, v3 row_newbcast:2 row_mask:0xf bank_mask:0x3
    v_and_b32_dpp v37, v25, v3 row_newbcast:2 row_mask:0xf bank_mask:0xc
    v_smfmac_f32_16x16x64_bf16 v[42:45], v[38:41], v[64:71], v32
    v_and_b32_dpp v38, v25, v3 row_newbcast:4 row_mask:0xf bank_mask:0x3
    v_and_b32_dpp v39, v25, v3 row_newbcast:4 row_mask:0xf bank_mask:0xc
    v_and_b32_dpp v40, v25, v3 row_newbcast:6 row_mask:0xf bank_mask:0x3
    v_and_b32_dpp v41, v25, v3 row_newbcast:6 row_mask:0xf bank_mask:0xc
    s_waitcnt lgkmcnt(2)
    v_smfmac_f32_16x16x64_bf16 v[42:45], v[34:37], v[4:11], v32
    ds_read_b128 v[4:7], v33 offset:8192
    ds_read_b128 v[8:11], v33 offset:9216
    v_and_b32_dpp v34, v25, v3 row_newbcast:8 row_mask:0xf bank_mask:0x3
    v_and_b32_dpp v35, v25, v3 row_newbcast:8 row_mask:0xf bank_mask:0xc
    v_and_b32_dpp v36, v25, v3 row_newbcast:10 row_mask:0xf bank_mask:0x3
    v_and_b32_dpp v37, v25, v3 row_newbcast:10 row_mask:0xf bank_mask:0xc
    v_smfmac_f32_16x16x64_bf16 v[42:45], v[38:41], v[72:79], v32
    v_and_b32_dpp v38, v25, v3 row_newbcast:12 row_mask:0xf bank_mask:0x3
    v_and_b32_dpp v39, v25, v3 row_newbcast:12 row_mask:0xf bank_mask:0xc
    v_and_b32_dpp v40, v25, v3 row_newbcast:14 row_mask:0xf bank_mask:0x3
    v_and_b32_dpp v41, v25, v3 row_newbcast:14 row_mask:0xf bank_mask:0xc
    s_waitcnt lgkmcnt(2)
    v_smfmac_f32_16x16x64_bf16 v[42:45], v[34:37], v[12:19], v32
    ds_read_b128 v[12:15], v33 offset:10240
    ds_read_b128 v[16:19], v33 offset:11264
    v_and_b32_dpp v34, v26, v3 row_newbcast:0 row_mask:0xf bank_mask:0x3
    v_and_b32_dpp v35, v26, v3 row_newbcast:0 row_mask:0xf bank_mask:0xc
    v_and_b32_dpp v36, v26, v3 row_newbcast:2 row_mask:0xf bank_mask:0x3
    v_and_b32_dpp v37, v26, v3 row_newbcast:2 row_mask:0xf bank_mask:0xc
    v_smfmac_f32_16x16x64_bf16 v[42:45], v[38:41], v[80:87], v32
    v_and_b32_dpp v38, v26, v3 row_newbcast:4 row_mask:0xf bank_mask:0x3
    v_and_b32_dpp v39, v26, v3 row_newbcast:4 row_mask:0xf bank_mask:0xc
    v_and_b32_dpp v40, v26, v3 row_newbcast:6 row_mask:0xf bank_mask:0x3
    v_and_b32_dpp v41, v26, v3 row_newbcast:6 row_mask:0xf bank_mask:0xc
    s_waitcnt lgkmcnt(2)
    v_smfmac_f32_16x16x64_bf16 v[42:45], v[34:37], v[4:11], v32
    ds_read_b128 v[48:51], v33 offset:12288
    v_and_b32_dpp v34, v26, v3 row_newbcast:8 row_mask:0xf bank_mask:0x3
    v_and_b32_dpp v35, v26, v3 row_newbcast:8 row_mask:0xf bank_mask:0xc
    v_and_b32_dpp v36, v26, v3 row_newbcast:10 row_mask:0xf bank_mask:0x3
    v_and_b32_dpp v37, v26, v3 row_newbcast:10 row_mask:0xf bank_mask:0xc
    v_smfmac_f32_16x16x64_bf16 v[42:45], v[38:41], v[88:95], v32
    s_cbranch_vccnz Lo_59
Lb_60:
    v_and_b32_dpp v38, v26, v3 row_newbcast:12 row_mask:0xf bank_mask:0x3
    v_and_b32_dpp v39, v26, v3 row_newbcast:12 row_mask:0xf bank_mask:0xc
    v_and_b32_dpp v40, v26, v3 row_newbcast:14 row_mask:0xf bank_mask:0x3
    v_and_b32_dpp v41, v26, v3 row_newbcast:14 row_mask:0xf bank_mask:0xc
    s_waitcnt lgkmcnt(1)
    v_smfmac_f32_16x16x64_bf16 v[42:45], v[34:37], v[12:19], v32
    v_and_b32_dpp v34, v27, v3 row_newbcast:0 row_mask:0xf bank_mask:0x3
    v_and_b32_dpp v35, v27, v3 row_newbcast:0 row_mask:0xf bank_mask:0xc
    v_and_b32_dpp v36, v27, v3 row_newbcast:2 row_mask:0xf bank_mask:0x3
    v_and_b32_dpp v37, v27, v3 row_newbcast:2 row_mask:0xf bank_mask:0xc
    v_smfmac_f32_16x16x64_bf16 v[42:45], v[38:41], v[96:103], v32
    v_and_b32_dpp v38, v27, v3 row_newbcast:4 row_mask:0xf bank_mask:0x3
    v_and_b32_dpp v39, v27, v3 row_newbcast:4 row_mask:0xf bank_mask:0xc
    v_and_b32_dpp v40, v27, v3 row_newbcast:6 row_mask:0xf bank_mask:0x3
    v_and_b32_dpp v41, v27, v3 row_newbcast:6 row_mask:0xf bank_mask:0xc
    s_waitcnt lgkmcnt(0)
    v_smfmac_f32_16x16x64_bf16 v[42:45], v[34:37], v[48:55], v32
    v_and_b32_dpp v34, v27, v3 row_newbcast:8 row_mask:0xf bank_mask:0x3
    v_and_b32_dpp v35, v27, v3 row_newbcast:8 row_mask:0xf bank_mask:0xc
    v_and_b32_dpp v36, v27, v3 row_newbcast:10 row_mask:0xf bank_mask:0x3
    v_and_b32_dpp v37, v27, v3 row_newbcast:10 row_mask:0xf bank_mask:0xc
    v_smfmac_f32_16x16x64_bf16 v[42:45], v[38:41], v[104:111], v32
    v_and_b32_dpp v38, v27, v3 row_newbcast:12 row_mask:0xf bank_mask:0x3
    v_and_b32_dpp v39, v27, v3 row_newbcast:12 row_mask:0xf bank_mask:0xc
    v_and_b32_dpp v40, v27, v3 row_newbcast:14 row_mask:0xf bank_mask:0x3
    v_and_b32_dpp v41, v27, v3 row_newbcast:14 row_mask:0xf bank_mask:0xc
    v_smfmac_f32_16x16x64_bf16 v[42:45], v[34:37], v[112:119], v32
    v_and_b32_dpp v34, v28, v3 row_newbcast:0 row_mask:0xf bank_mask:0x3
    v_and_b32_dpp v35, v28, v3 row_newbcast:0 row_mask:0xf bank_mask:0xc
    v_and_b32_dpp v36, v28, v3 row_newbcast:2 row_mask:0xf bank_mask:0x3
    v_and_b32_dpp v37, v28, v3 row_newbcast:2 row_mask:0xf bank_mask:0xc
    v_smfmac_f32_16x16x64_bf16 v[42:45], v[38:41], v[120:127], v32
    v_and_b32_dpp v38, v28, v3 row_newbcast:4 row_mask:0xf bank_mask:0x3
    v_and_b32_dpp v39, v28, v3 row_newbcast:4 row_mask:0xf bank_mask:0xc
    v_and_b32_dpp v40, v28, v3 row_newbcast:6 row_mask:0xf bank_mask:0x3
    v_and_b32_dpp v41, v28, v3 row_newbcast:6 row_mask:0xf bank_mask:0xc
    v_smfmac_f32_16x16x64_bf16 v[42:45], v[34:37], v[128:135], v32
    v_and_b32_dpp v34, v28, v3 row_newbcast:8 row_mask:0xf bank_mask:0x3
    v_and_b32_dpp v35, v28, v3 row_newbcast:8 row_mask:0xf bank_mask:0xc
    v_and_b32_dpp v36, v28, v3 row_newbcast:10 row_mask:0xf bank_mask:0x3
    v_and_b32_dpp v37, v28, v3 row_newbcast:10 row_mask:0xf bank_mask:0xc
    v_smfmac_f32_16x16x64_bf16 v[42:45], v[38:41], v[136:143], v32
    s_cbranch_vccnz Lo_61
Lb_62:
    v_and_b32_dpp v38, v28, v3 row_newbcast:12 row_mask:0xf bank_mask:0x3
    v_and_b32_dpp v39, v28, v3 row_newbcast:12 row_mask:0xf bank_mask:0xc
    v_and_b32_dpp v40, v28, v3 row_newbcast:14 row_mask:0xf bank_mask:0x3
    v_and_b32_dpp v41, v28, v3 row_newbcast:14 row_mask:0xf bank_mask:0xc
    v_smfmac_f32_16x16x64_bf16 v[42:45], v[34:37], v[144:151], v32
    v_and_b32_dpp v34, v29, v3 row_newbcast:0 row_mask:0xf bank_mask:0x3
    v_and_b32_dpp v35, v29, v3 row_newbcast:0 row_mask:0xf bank_mask:0xc
    v_and_b32_dpp v36, v29, v3 row_newbcast:2 row_mask:0xf bank_mask:0x3
    v_and_b32_dpp v37, v29, v3 row_newbcast:2 row_mask:0xf bank_mask:0xc
    v_smfmac_f32_16x16x64_bf16 v[42:45], v[38:41], v[152:159], v32
    v_and_b32_dpp v38, v29, v3 row_newbcast:4 row_mask:0xf bank_mask:0x3
    v_and_b32_dpp v39, v29, v3 row_newbcast:4 row_mask:0xf bank_mask:0xc
    v_and_b32_dpp v40, v29, v3 row_newbcast:6 row_mask:0xf bank_mask:0x3
    v_and_b32_dpp v41, v29, v3 row_newbcast:6 row_mask:0xf bank_mask:0xc
    v_smfmac_f32_16x16x64_bf16 v[42:45], v[34:37], v[160:167], v32
    v_and_b32_dpp v34, v29, v3 row_newbcast:8 row_mask:0xf bank_mask:0x3
    v_and_b32_dpp v35, v29, v3 row_newbcast:8 row_mask:0xf bank_mask:0xc
    v_and_b32_dpp v36, v29, v3 row_newbcast:10 row_mask:0xf bank_mask:0x3
    v_and_b32_dpp v37, v29, v3 row_newbcast:10 row_mask:0xf bank_mask:0xc
    v_smfmac_f32_16x16x64_bf16 v[42:45], v[38:41], v[168:175], v32
    v_and_b32_dpp v38, v29, v3 row_newbcast:12 row_mask:0xf bank_mask:0x3
    v_and_b32_dpp v39, v29, v3 row_newbcast:12 row_mask:0xf bank_mask:0xc
    v_and_b32_dpp v40, v29, v3 row_newbcast:14 row_mask:0xf bank_mask:0x3
    v_and_b32_dpp v41, v29, v3 row_newbcast:14 row_mask:0xf bank_mask:0xc
    v_smfmac_f32_16x16x64_bf16 v[42:45], v[34:37], v[176:183], v32
    v_and_b32_dpp v34, v30, v3 row_newbcast:0 row_mask:0xf bank_mask:0x3
    v_and_b32_dpp v35, v30, v3 row_newbcast:0 row_mask:0xf bank_mask:0xc
    v_and_b32_dpp v36, v30, v3 row_newbcast:2 row_mask:0xf bank_mask:0x3
    v_and_b32_dpp v37, v30, v3 row_newbcast:2 row_mask:0xf bank_mask:0xc
    v_smfmac_f32_16x16x64_bf16 v[42:45], v[38:41], v[184:191], v32
    v_and_b32_dpp v38, v30, v3 row_newbcast:4 row_mask:0xf bank_mask:0x3
    v_and_b32_dpp v39, v30, v3 row_newbcast:4 row_mask:0xf bank_mask:0xc
    v_and_b32_dpp v40, v30, v3 row_newbcast:6 row_mask:0xf bank_mask:0x3
    v_and_b32_dpp v41, v30, v3 row_newbcast:6 row_mask:0xf bank_mask:0xc
    v_smfmac_f32_16x16x64_bf16 v[42:45], v[34:37], v[192:199], v32
    v_and_b32_dpp v34, v30, v3 row_newbcast:8 row_mask:0xf bank_mask:0x3
    v_and_b32_dpp v35, v30, v3 row_newbcast:8 row_mask:0xf bank_mask:0xc
    v_and_b32_dpp v36, v30, v3 row_newbcast:10 row_mask:0xf bank_mask:0x3
    v_and_b32_dpp v37, v30, v3 row_newbcast:10 row_mask:0xf bank_mask:0xc
    v_smfmac_f32_16x16x64_bf16 v[42:45], v[38:41], v[200:207], v32
    s_cbranch_vccnz Lo_63
Lb_64:
    v_and_b32_dpp v38, v30, v3 row_newbcast:12 row_mask:0xf bank_mask:0x3
    v_and_b32_dpp v39, v30, v3 row_newbcast:12 row_mask:0xf bank_mask:0xc
    v_and_b32_dpp v40, v30, v3 row_newbcast:14 row_mask:0xf bank_mask:0x3
    v_and_b32_dpp v41, v30, v3 row_newbcast:14 row_mask:0xf bank_mask:0xc
    v_smfmac_f32_16x16x64_bf16 v[42:45], v[34:37], v[208:215], v32
    v_and_b32_dpp v34, v31, v3 row_newbcast:0 row_mask:0xf bank_mask:0x3
    v_and_b32_dpp v35, v31, v3 row_newbcast:0 row_mask:0xf bank_mask:0xc
    v_and_b32_dpp v36, v31, v3 row_newbcast:2 row_mask:0xf bank_mask:0x3
    v_and_b32_dpp v37, v31, v3 row_newbcast:2 row_mask:0xf bank_mask:0xc
    v_smfmac_f32_16x16x64_bf16 v[42:45], v[38:41], v[216:223], v32
    v_and_b32_dpp v38, v31, v3 row_newbcast:4 row_mask:0xf bank_mask:0x3
    v_and_b32_dpp v39, v31, v3 row_newbcast:4 row_mask:0xf bank_mask:0xc
    v_and_b32_dpp v40, v31, v3 row_newbcast:6 row_mask:0xf bank_mask:0x3
    v_and_b32_dpp v41, v31, v3 row_newbcast:6 row_mask:0xf bank_mask:0xc
    v_smfmac_f32_16x16x64_bf16 v[42:45], v[34:37], v[224:231], v32
    v_and_b32_dpp v34, v31, v3 row_newbcast:8 row_mask:0xf bank_mask:0x3
    v_and_b32_dpp v35, v31, v3 row_newbcast:8 row_mask:0xf bank_mask:0xc
    v_and_b32_dpp v36, v31, v3 row_newbcast:10 row_mask:0xf bank_mask:0x3
    v_and_b32_dpp v37, v31, v3 row_newbcast:10 row_mask:0xf bank_mask:0xc
    v_smfmac_f32_16x16x64_bf16 v[42:45], v[38:41], v[232:239], v32
    v_and_b32_dpp v38, v31, v3 row_newbcast:12 row_mask:0xf bank_mask:0x3
    v_and_b32_dpp v39, v31, v3 row_newbcast:12 row_mask:0xf bank_mask:0xc
    v_and_b32_dpp v40, v31, v3 row_newbcast:14 row_mask:0xf bank_mask:0x3
    v_and_b32_dpp v41, v31, v3 row_newbcast:14 row_mask:0xf bank_mask:0xc
    v_smfmac_f32_16x16x64_bf16 v[42:45], v[34:37], v[240:247], v32
    s_nop 0
    v_smfmac_f32_16x16x64_bf16 v[42:45], v[38:41], v[248:255], v32
L_att_epi:
    s_nop 3
    v_and_b32 v32, 1, v0
    v_lshlrev_b32 v32, 5, v32
    s_lshl_b32 s70, s3, 2
    s_add_u32 s70, s70, s64
    s_add_u32 s70, s70, 4096
    v_add_u32 v32, s70, v32
    ds_write2_b32 v32, v46, v20 offset0:0 offset1:4
    v_add_u32 v32, s64, v2
    v_lshrrev_b32 v33, 5, v0
    v_lshlrev_b32 v34, 6, v33
    v_lshlrev_b32 v33, 5, v33
    v_add_u32 v33, s64, v33
    ds_write_b128 v47, v[42:45]
    s_lshl_b32 s70, s2, 10
    s_add_u32 s70, s70, s58
    s_lshl_b32 s71, s4, 7
    s_add_u32 s71, s71, s59
    s_lshl_b32 s72, s6, 2
    s_add_u32 s71, s71, s72
    s_cmp_lg_u32 s3, 0
    s_waitcnt lgkmcnt(0)
    s_barrier
    s_cbranch_scc1 L_att_ret
    ds_read_b128 v[20:23], v33 offset:4096
    ds_read_b128 v[24:27], v33 offset:4112
    ds_read_b128 v[4:7], v32
    ds_read_b128 v[8:11], v32 offset:1024
    ds_read_b128 v[12:15], v32 offset:2048
    ds_read_b128 v[16:19], v32 offset:3072
    s_waitcnt lgkmcnt(4)
    v_max3_f32 v28, v20, v21, v22
    v_max_f32 v28, v28, v23
    v_mul_f32 v28, s26, v28
    v_fma_f32 v20, v20, s26, -v28
    v_fma_f32 v21, v21, s26, -v28
    v_fma_f32 v22, v22, s26, -v28
    v_fma_f32 v23, v23, s26, -v28
    v_exp_f32 v20, v20
    v_exp_f32 v21, v21
    v_exp_f32 v22, v22
    v_exp_f32 v23, v23
    v_mul_f32 v30, v20, v24
    v_fmac_f32 v30, v21, v25
    v_fmac_f32 v30, v22, v26
    v_fmac_f32 v30, v23, v27
    s_waitcnt lgkmcnt(0)
    v_pk_mul_f32 v[4:5], v[4:5], v[20:21] op_sel:[0,0] op_sel_hi:[1,0]
    v_log_f32 v29, v30
    v_rcp_f32 v30, v30
    v_pk_mul_f32 v[6:7], v[6:7], v[20:21] op_sel:[0,0] op_sel_hi:[1,0]
    v_pk_fma_f32 v[4:5], v[8:9], v[20:21], v[4:5] op_sel:[0,1,0] op_sel_hi:[1,1,1]
    v_pk_fma_f32 v[6:7], v[10:11], v[20:21], v[6:7] op_sel:[0,1,0] op_sel_hi:[1,1,1]
    v_pk_fma_f32 v[4:5], v[12:13], v[22:23], v[4:5] op_sel:[0,0,0] op_sel_hi:[1,0,1]
    v_pk_fma_f32 v[6:7], v[14:15], v[22:23], v[6:7] op_sel:[0,0,0] op_sel_hi:[1,0,1]
    v_pk_fma_f32 v[4:5], v[16:17], v[22:23], v[4:5] op_sel:[0,1,0] op_sel_hi:[1,1,1]
    v_pk_fma_f32 v[6:7], v[18:19], v[22:23], v[6:7] op_sel:[0,1,0] op_sel_hi:[1,1,1]
    v_pk_mul_f32 v[4:5], v[4:5], v[30:31] op_sel:[0,0] op_sel_hi:[1,0]
    v_pk_mul_f32 v[6:7], v[6:7], v[30:31] op_sel:[0,0] op_sel_hi:[1,0]
    v_add_f32 v29, v29, v28
    s_cmp_eq_u32 s33, 0
    s_cbranch_scc1 Lgs_65
    buffer_store_dwordx4 v[4:7], v2, s[16:19], s70 offen
    s_mov_b32 exec_lo, 1
    s_mov_b32 exec_hi, 1
    buffer_store_dword v29, v34, s[16:19], s71 offen
    s_mov_b64 exec, -1
Lgb_66:
L_att_ret:
    s_setpc_b64 s[30:31]
Lo_53:
    s_call_b64 s[80:81], SUB_LN
    s_branch Lb_54
Lo_55:
    s_call_b64 s[80:81], SUB_LN
    s_branch Lb_56
Lo_57:
    s_call_b64 s[80:81], SUB_LN
    s_branch Lb_58
Lo_59:
    s_call_b64 s[80:81], SUB_LN
    s_branch Lb_60
Lo_61:
    s_call_b64 s[80:81], SUB_LN
    s_branch Lb_62
Lo_63:
    s_call_b64 s[80:81], SUB_LN
    s_branch Lb_64
SUB_LN:
    s_cmp_eq_u32 s42, 0
    s_cbranch_scc1 L_ln_nt
    s_waitcnt vmcnt(3)
L_ln_nt:
    s_cmp_eq_u32 s82, 0
    s_cbranch_scc1 L_lnb0
    s_cmp_eq_u32 s82, 1
    s_cbranch_scc1 L_lnb1
    s_cmp_eq_u32 s82, 2
    s_cbranch_scc1 L_lnb2
    s_cmp_eq_u32 s82, 3
    s_cbranch_scc1 L_lnb3
    s_cmp_eq_u32 s82, 4
    s_cbranch_scc1 L_lnb4
    s_cmp_eq_u32 s82, 5
    s_cbranch_scc1 L_lnb5
    s_cmp_eq_u32 s82, 6
    s_cbranch_scc1 L_lnb6
    s_cmp_eq_u32 s82, 7
    s_cbranch_scc1 L_lnb7
    s_cmp_eq_u32 s82, 8
    s_cbranch_scc1 L_lnb8
    s_cmp_eq_u32 s82, 9
    s_cbranch_scc1 L_lnb9
    s_cmp_eq_u32 s82, 10
    s_cbranch_scc1 L_lnb10
    s_cmp_eq_u32 s82, 11
    s_cbranch_scc1 L_lnb11
    s_cmp_eq_u32 s82, 12
    s_cbranch_scc1 L_lnb12
    s_cmp_eq_u32 s82, 13
    s_cbranch_scc1 L_lnb13
    s_cmp_eq_u32 s82, 14
    s_cbranch_scc1 L_lnb14
L_lnb15:
    s_add_u32 s28, s27, 57344
    buffer_load_dwordx4 v[224:227], v2, s[12:15], s28 offen offset:0 nt
    buffer_load_dwordx4 v[228:231], v2, s[12:15], s28 offen offset:1024 nt
    buffer_load_dwordx4 v[232:235], v2, s[12:15], s28 offen offset:2048 nt
    buffer_load_dwordx4 v[236:239], v2, s[12:15], s28 offen offset:3072 nt
    s_cmp_eq_u32 s42, 0
    s_cbranch_scc1 L_lnm15
    s_waitcnt vmcnt(4)
L_lnm15:
    s_add_u32 s28, s27, 61440
    buffer_load_dwordx4 v[240:243], v2, s[12:15], s28 offen offset:0 nt
    buffer_load_dwordx4 v[244:247], v2, s[12:15], s28 offen offset:1024 nt
    buffer_load_dwordx4 v[248:251], v2, s[12:15], s28 offen offset:2048 nt
    buffer_load_dwordx4 v[252:255], v2, s[12:15], s28 offen offset:3072 nt
    s_add_u32 s82, s82, 1
    s_setpc_b64 s[80:81]
L_lnb0:
    s_add_u32 s28, s27, 0
    buffer_load_dwordx4 a[0:3], v1, s[8:11], s28 offen offset:0 nt
    buffer_load_dwordx4 a[4:7], v1, s[8:11], s28 offen offset:128 nt
    buffer_load_dwordx4 a[8:11], v1, s[8:11], s28 offen offset:512 nt
    buffer_load_dwordx4 a[12:15], v1, s[8:11], s28 offen offset:640 nt
    s_cmp_eq_u32 s42, 0
    s_cbranch_scc1 L_lnm0
    s_waitcnt vmcnt(4)
L_lnm0:
    s_add_u32 s28, s27, 0
    buffer_load_dwordx4 a[16:19], v1, s[8:11], s28 offen offset:1024 nt
    buffer_load_dwordx4 a[20:23], v1, s[8:11], s28 offen offset:1152 nt
    buffer_load_dwordx4 a[24:27], v1, s[8:11], s28 offen offset:1536 nt
    buffer_load_dwordx4 a[28:31], v1, s[8:11], s28 offen offset:1664 nt
    s_add_u32 s82, s82, 1
    s_setpc_b64 s[80:81]
L_lnb1:
    s_add_u32 s28, s27, 8192
    buffer_load_dwordx4 a[32:35], v1, s[8:11], s28 offen offset:0 nt
    buffer_load_dwordx4 a[36:39], v1, s[8:11], s28 offen offset:128 nt
    buffer_load_dwordx4 a[40:43], v1, s[8:11], s28 offen offset:512 nt
    buffer_load_dwordx4 a[44:47], v1, s[8:11], s28 offen offset:640 nt
    s_cmp_eq_u32 s42, 0
    s_cbranch_scc1 L_lnm1
    s_waitcnt vmcnt(4)
L_lnm1:
    s_add_u32 s28, s27, 8192
    buffer_load_dwordx4 a[48:51], v1, s[8:11], s28 offen offset:1024 nt
    buffer_load_dwordx4 a[52:55], v1, s[8:11], s28 offen offset:1152 nt
    buffer_load_dwordx4 a[56:59], v1, s[8:11], s28 offen offset:1536 nt
    buffer_load_dwordx4 a[60:63], v1, s[8:11], s28 offen offset:1664 nt
    s_add_u32 s82, s82, 1
    s_setpc_b64 s[80:81]
L_lnb2:
    s_add_u32 s28, s27, 16384
    buffer_load_dwordx4 a[64:67], v1, s[8:11], s28 offen offset:0 nt
    buffer_load_dwordx4 a[68:71], v1, s[8:11], s28 offen offset:128 nt
    buffer_load_dwordx4 a[72:75], v1, s[8:11], s28 offen offset:512 nt
    buffer_load_dwordx4 a[76:79], v1, s[8:11], s28 offen offset:640 nt
    s_cmp_eq_u32 s42, 0
    s_cbranch_scc1 L_lnm2
    s_waitcnt vmcnt(4)
L_lnm2:
    s_add_u32 s28, s27, 16384
    buffer_load_dwordx4 a[80:83], v1, s[8:11], s28 offen offset:1024 nt
    buffer_load_dwordx4 a[84:87], v1, s[8:11], s28 offen offset:1152 nt
    buffer_load_dwordx4 a[88:91], v1, s[8:11], s28 offen offset:1536 nt
    buffer_load_dwordx4 a[92:95], v1, s[8:11], s28 offen offset:1664 nt
    s_add_u32 s82, s82, 1
    s_setpc_b64 s[80:81]
L_lnb3:
    s_add_u32 s28, s27, 24576
    buffer_load_dwordx4 a[96:99], v1, s[8:11], s28 offen offset:0 nt
    buffer_load_dwordx4 a[100:103], v1, s[8:11], s28 offen offset:128 nt
    buffer_load_dwordx4 a[104:107], v1, s[8:11], s28 offen offset:512 nt
    buffer_load_dwordx4 a[108:111], v1, s[8:11], s28 offen offset:640 nt
    s_cmp_eq_u32 s42, 0
    s_cbranch_scc1 L_lnm3
    s_waitcnt vmcnt(4)
L_lnm3:
    s_add_u32 s28, s27, 24576
    buffer_load_dwordx4 a[112:115], v1, s[8:11], s28 offen offset:1024 nt
    buffer_load_dwordx4 a[116:119], v1, s[8:11], s28 offen offset:1152 nt
    buffer_load_dwordx4 a[120:123], v1, s[8:11], s28 offen offset:1536 nt
    buffer_load_dwordx4 a[124:127], v1, s[8:11], s28 offen offset:1664 nt
    s_add_u32 s82, s82, 1
    s_setpc_b64 s[80:81]
L_lnb4:
    s_add_u32 s28, s27, 32768
    buffer_load_dwordx4 a[128:131], v1, s[8:11], s28 offen offset:0 nt
    buffer_load_dwordx4 a[132:135], v1, s[8:11], s28 offen offset:128 nt
    buffer_load_dwordx4 a[136:139], v1, s[8:11], s28 offen offset:512 nt
    buffer_load_dwordx4 a[140:143], v1, s[8:11], s28 offen offset:640 nt
    s_cmp_eq_u32 s42, 0
    s_cbranch_scc1 L_lnm4
    s_waitcnt vmcnt(4)
L_lnm4:
    s_add_u32 s28, s27, 32768
    buffer_load_dwordx4 a[144:147], v1, s[8:11], s28 offen offset:1024 nt
    buffer_load_dwordx4 a[148:151], v1, s[8:11], s28 offen offset:1152 nt
    buffer_load_dwordx4 a[152:155], v1, s[8:11], s28 offen offset:1536 nt
    buffer_load_dwordx4 a[156:159], v1, s[8:11], s28 offen offset:1664 nt
    s_add_u32 s82, s82, 1
    s_setpc_b64 s[80:81]
L_lnb5:
    s_add_u32 s28, s27, 40960
    buffer_load_dwordx4 a[160:163], v1, s[8:11], s28 offen offset:0 nt
    buffer_load_dwordx4 a[164:167], v1, s[8:11], s28 offen offset:128 nt
    buffer_load_dwordx4 a[168:171], v1, s[8:11], s28 offen offset:512 nt
    buffer_load_dwordx4 a[172:175], v1, s[8:11], s28 offen offset:640 nt
    s_cmp_eq_u32 s42, 0
    s_cbranch_scc1 L_lnm5
    s_waitcnt vmcnt(4)
L_lnm5:
    s_add_u32 s28, s27, 40960
    buffer_load_dwordx4 a[176:179], v1, s[8:11], s28 offen offset:1024 nt
    buffer_load_dwordx4 a[180:183], v1, s[8:11], s28 offen offset:1152 nt
    buffer_load_dwordx4 a[184:187], v1, s[8:11], s28 offen offset:1536 nt
    buffer_load_dwordx4 a[188:191], v1, s[8:11], s28 offen offset:1664 nt
    s_add_u32 s82, s82, 1
    s_setpc_b64 s[80:81]
L_lnb6:
    s_add_u32 s28, s27, 49152
    buffer_load_dwordx4 a[192:195], v1, s[8:11], s28 offen offset:0 nt
    buffer_load_dwordx4 a[196:199], v1, s[8:11], s28 offen offset:128 nt
    buffer_load_dwordx4 a[200:203], v1, s[8:11], s28 offen offset:512 nt
    buffer_load_dwordx4 a[204:207], v1, s[8:11], s28 offen offset:640 nt
    s_cmp_eq_u32 s42, 0
    s_cbranch_scc1 L_lnm6
    s_waitcnt vmcnt(4)
L_lnm6:
    s_add_u32 s28, s27, 49152
    buffer_load_dwordx4 a[208:211], v1, s[8:11], s28 offen offset:1024 nt
    buffer_load_dwordx4 a[212:215], v1, s[8:11], s28 offen offset:1152 nt
    buffer_load_dwordx4 a[216:219], v1, s[8:11], s28 offen offset:1536 nt
    buffer_load_dwordx4 a[220:223], v1, s[8:11], s28 offen offset:1664 nt
    s_add_u32 s82, s82, 1
    s_setpc_b64 s[80:81]
L_lnb7:
    s_add_u32 s28, s27, 57344
    buffer_load_dwordx4 a[224:227], v1, s[8:11], s28 offen offset:0 nt
    buffer_load_dwordx4 a[228:231], v1, s[8:11], s28 offen offset:128 nt
    buffer_load_dwordx4 a[232:235], v1, s[8:11], s28 offen offset:512 nt
    buffer_load_dwordx4 a[236:239], v1, s[8:11], s28 offen offset:640 nt
    s_cmp_eq_u32 s42, 0
    s_cbranch_scc1 L_lnm7
    s_waitcnt vmcnt(4)
L_lnm7:
    s_add_u32 s28, s27, 57344
    buffer_load_dwordx4 a[240:243], v1, s[8:11], s28 offen offset:1024 nt
    buffer_load_dwordx4 a[244:247], v1, s[8:11], s28 offen offset:1152 nt
    buffer_load_dwordx4 a[248:251], v1, s[8:11], s28 offen offset:1536 nt
    buffer_load_dwordx4 a[252:255], v1, s[8:11], s28 offen offset:1664 nt
    s_add_u32 s82, s82, 1
    s_setpc_b64 s[80:81]
L_lnb8:
    s_add_u32 s28, s27, 0
    s_add_u32 m0, s29, 0
    s_nop 0
    buffer_load_dwordx4 v2, s[12:15], s28 offen offset:0 nt lds
    buffer_load_dwordx4 v2, s[12:15], s28 offen offset:1024 nt lds
    buffer_load_dwordx4 v[56:59], v2, s[12:15], s28 offen offset:2048 nt
    buffer_load_dwordx4 v[60:63], v2, s[12:15], s28 offen offset:3072 nt
    s_cmp_eq_u32 s42, 0
    s_cbranch_scc1 L_lnm8
    s_waitcnt vmcnt(4)
L_lnm8:
    s_add_u32 s28, s27, 4096
    s_add_u32 m0, s29, 2048
    s_nop 0
    buffer_load_dwordx4 v2, s[12:15], s28 offen offset:0 nt lds
    buffer_load_dwordx4 v2, s[12:15], s28 offen offset:1024 nt lds
    buffer_load_dwordx4 v[64:67], v2, s[12:15], s28 offen offset:2048 nt
    buffer_load_dwordx4 v[68:71], v2, s[12:15], s28 offen offset:3072 nt
    s_add_u32 s82, s82, 1
    s_setpc_b64 s[80:81]
L_lnb9:
    s_add_u32 s28, s27, 8192
    s_add_u32 m0, s29, 4096
    s_nop 0
    buffer_load_dwordx4 v2, s[12:15], s28 offen offset:0 nt lds
    buffer_load_dwordx4 v2, s[12:15], s28 offen offset:1024 nt lds
    buffer_load_dwordx4 v[72:75], v2, s[12:15], s28 offen offset:2048 nt
    buffer_load_dwordx4 v[76:79], v2, s[12:15], s28 offen offset:3072 nt
    s_cmp_eq_u32 s42, 0
    s_cbranch_scc1 L_lnm9
    s_waitcnt vmcnt(4)
L_lnm9:
    s_add_u32 s28, s27, 12288
    s_add_u32 m0, s29, 6144
    s_nop 0
    buffer_load_dwordx4 v2, s[12:15], s28 offen offset:0 nt lds
    buffer_load_dwordx4 v2, s[12:15], s28 offen offset:1024 nt lds
    buffer_load_dwordx4 v[80:83], v2, s[12:15], s28 offen offset:2048 nt
    buffer_load_dwordx4 v[84:87], v2, s[12:15], s28 offen offset:3072 nt
    s_add_u32 s82, s82, 1
    s_setpc_b64 s[80:81]
L_lnb10:
    s_add_u32 s28, s27, 16384
    s_add_u32 m0, s29, 8192
    s_nop 0
    buffer_load_dwordx4 v2, s[12:15], s28 offen offset:0 nt lds
    buffer_load_dwordx4 v2, s[12:15], s28 offen offset:1024 nt lds
    buffer_load_dwordx4 v[88:91], v2, s[12:15], s28 offen offset:2048 nt
    buffer_load_dwordx4 v[92:95], v2, s[12:15], s28 offen offset:3072 nt
    s_cmp_eq_u32 s42, 0
    s_cbranch_scc1 L_lnm10
    s_waitcnt vmcnt(4)
L_lnm10:
    s_add_u32 s28, s27, 20480
    s_add_u32 m0, s29, 10240
    s_nop 0
    buffer_load_dwordx4 v2, s[12:15], s28 offen offset:0 nt lds
    buffer_load_dwordx4 v2, s[12:15], s28 offen offset:1024 nt lds
    buffer_load_dwordx4 v[96:99], v2, s[12:15], s28 offen offset:2048 nt
    buffer_load_dwordx4 v[100:103], v2, s[12:15], s28 offen offset:3072 nt
    s_add_u32 s82, s82, 1
    s_setpc_b64 s[80:81]
L_lnb11:
    s_add_u32 s28, s27, 24576
    s_add_u32 m0, s29, 12288
    s_nop 0
    buffer_load_dwordx4 v2, s[12:15], s28 offen offset:0 nt lds
    buffer_load_dwordx4 v[52:55], v2, s[12:15], s28 offen offset:1024 nt
    buffer_load_dwordx4 v[104:107], v2, s[12:15], s28 offen offset:2048 nt
    buffer_load_dwordx4 v[108:111], v2, s[12:15], s28 offen offset:3072 nt
    s_cmp_eq_u32 s42, 0
    s_cbranch_scc1 L_lnm11
    s_waitcnt vmcnt(4)
L_lnm11:
    s_add_u32 s28, s27, 28672
    buffer_load_dwordx4 v[112:115], v2, s[12:15], s28 offen offset:0 nt
    buffer_load_dwordx4 v[116:119], v2, s[12:15], s28 offen offset:1024 nt
    buffer_load_dwordx4 v[120:123], v2, s[12:15], s28 offen offset:2048 nt
    buffer_load_dwordx4 v[124:127], v2, s[12:15], s28 offen offset:3072 nt
    s_add_u32 s82, s82, 1
    s_setpc_b64 s[80:81]
L_lnb12:
    s_add_u32 s28, s27, 32768
    buffer_load_dwordx4 v[128:131], v2, s[12:15], s28 offen offset:0 nt
    buffer_load_dwordx4 v[132:135], v2, s[12:15], s28 offen offset:1024 nt
    buffer_load_dwordx4 v[136:139], v2, s[12:15], s28 offen offset:2048 nt
    buffer_load_dwordx4 v[140:143], v2, s[12:15], s28 offen offset:3072 nt
    s_cmp_eq_u32 s42, 0
    s_cbranch_scc1 L_lnm12
    s_waitcnt vmcnt(4)
L_lnm12:
    s_add_u32 s28, s27, 36864
    buffer_load_dwordx4 v[144:147], v2, s[12:15], s28 offen offset:0 nt
    buffer_load_dwordx4 v[148:151], v2, s[12:15], s28 offen offset:1024 nt
    buffer_load_dwordx4 v[152:155], v2, s[12:15], s28 offen offset:2048 nt
    buffer_load_dwordx4 v[156:159], v2, s[12:15], s28 offen offset:3072 nt
    s_add_u32 s82, s82, 1
    s_setpc_b64 s[80:81]
L_lnb13:
    s_add_u32 s28, s27, 40960
    buffer_load_dwordx4 v[160:163], v2, s[12:15], s28 offen offset:0 nt
    buffer_load_dwordx4 v[164:167], v2, s[12:15], s28 offen offset:1024 nt
    buffer_load_dwordx4 v[168:171], v2, s[12:15], s28 offen offset:2048 nt
    buffer_load_dwordx4 v[172:175], v2, s[12:15], s28 offen offset:3072 nt
    s_cmp_eq_u32 s42, 0
    s_cbranch_scc1 L_lnm13
    s_waitcnt vmcnt(4)
L_lnm13:
    s_add_u32 s28, s27, 45056
    buffer_load_dwordx4 v[176:179], v2, s[12:15], s28 offen offset:0 nt
    buffer_load_dwordx4 v[180:183], v2, s[12:15], s28 offen offset:1024 nt
    buffer_load_dwordx4 v[184:187], v2, s[12:15], s28 offen offset:2048 nt
    buffer_load_dwordx4 v[188:191], v2, s[12:15], s28 offen offset:3072 nt
    s_add_u32 s82, s82, 1
    s_setpc_b64 s[80:81]
L_lnb14:
    s_add_u32 s28, s27, 49152
    buffer_load_dwordx4 v[192:195], v2, s[12:15], s28 offen offset:0 nt
    buffer_load_dwordx4 v[196:199], v2, s[12:15], s28 offen offset:1024 nt
    buffer_load_dwordx4 v[200:203], v2, s[12:15], s28 offen offset:2048 nt
    buffer_load_dwordx4 v[204:207], v2, s[12:15], s28 offen offset:3072 nt
    s_cmp_eq_u32 s42, 0
    s_cbranch_scc1 L_lnm14
    s_waitcnt vmcnt(4)
L_lnm14:
    s_add_u32 s28, s27, 53248
    buffer_load_dwordx4 v[208:211], v2, s[12:15], s28 offen offset:0 nt
    buffer_load_dwordx4 v[212:215], v2, s[12:15], s28 offen offset:1024 nt
    buffer_load_dwordx4 v[216:219], v2, s[12:15], s28 offen offset:2048 nt
    buffer_load_dwordx4 v[220:223], v2, s[12:15], s28 offen offset:3072 nt
    s_add_u32 s82, s82, 1
    s_setpc_b64 s[80:81]
SUB_LNW:
    s_mov_b32 s36, 0
L_lnw_i:
    s_call_b64 s[80:81], SUB_LN
    s_add_u32 s36, s36, 8
L_lnw_c:
    s_getreg_b32 s37, hwreg(HW_REG_IB_STS)
    s_and_b32 s28, s37, 15
    s_lshr_b32 s37, s37, 18
    s_and_b32 s37, s37, 0x30
    s_or_b32 s37, s37, s28
    s_cmp_le_u32 s37, s36
    s_cbranch_scc1 L_lnw_r
    s_cmp_ge_u32 s82, 16
    s_cbranch_scc1 L_lnw_s
    s_cmp_lt_u32 s37, 40
    s_cbranch_scc1 L_lnw_i
L_lnw_s:
    s_sleep 1
    s_branch L_lnw_c
L_lnw_r:
    s_cmp_gt_u32 s36, 8
    s_cbranch_scc1 L_lnw_r8
    s_waitcnt vmcnt(8)
    s_setpc_b64 s[34:35]
L_lnw_r8:
    s_cmp_gt_u32 s36, 16
    s_cbranch_scc1 L_lnw_r16
    s_waitcnt vmcnt(16)
    s_setpc_b64 s[34:35]
L_lnw_r16:
    s_cmp_gt_u32 s36, 24
    s_cbranch_scc1 L_lnw_r24
    s_waitcnt vmcnt(24)
    s_setpc_b64 s[34:35]
L_lnw_r24:
    s_cmp_gt_u32 s36, 32
    s_cbranch_scc1 L_lnw_r32
    s_waitcnt vmcnt(32)
    s_setpc_b64 s[34:35]
L_lnw_r32:
    s_cmp_gt_u32 s36, 40
    s_cbranch_scc1 L_lnw_r40
    s_waitcnt vmcnt(40)
    s_setpc_b64 s[34:35]
L_lnw_r40:
    s_waitcnt vmcnt(48)
    s_setpc_b64 s[34:35]
SUB_CH1:
    v_lshrrev_b32 v21, 4, v0
    v_bfe_u32 v22, v0, 2, 2
    v_lshl_add_u32 v23, v21, 3, v22
    v_lshlrev_b32 v23, 7, v23
    v_bfe_u32 v21, v0, 3, 2
    v_xor_b32 v21, s3, v21
    v_lshl_add_u32 v23, v21, 5, v23
    v_and_b32 v21, 3, v0
    v_lshl_add_u32 v23, v21, 3, v23
    v_add_u32 v23, 53248, v23
    ds_read_b64_tr_b16 v[24:25], v23 offset:0
    ds_read_b64_tr_b16 v[26:27], v23 offset:512
    ds_read_b64_tr_b16 v[28:29], v23 offset:4096
    ds_read_b64_tr_b16 v[30:31], v23 offset:4608
    ds_read_b64_tr_b16 v[32:33], v23 offset:8192
    ds_read_b64_tr_b16 v[34:35], v23 offset:8704
    ds_read_b64_tr_b16 v[36:37], v23 offset:12288
    ds_read_b64_tr_b16 v[38:39], v23 offset:12800
    ds_read_b64_tr_b16 v[40:41], v23 offset:16384
    ds_read_b64_tr_b16 v[42:43], v23 offset:16896
    ds_read_b64_tr_b16 v[44:45], v23 offset:20480
    ds_read_b64_tr_b16 v[46:47], v23 offset:20992
    ds_read_b64_tr_b16 v[48:49], v23 offset:24576
    ds_read_b64_tr_b16 v[50:51], v23 offset:25088
    v_lshlrev_b32 v21, 2, v0
    s_lshl_b32 s70, s4, 14
    s_add_u32 s70, s70, s58
    s_lshl_b32 s71, s3, 8
    s_add_u32 s70, s70, s71
    s_add_u32 s71, s70, 4096
    s_add_u32 s72, s70, 8192
    s_add_u32 s73, s70, 12288
    s_lshl_b32 s74, s4, 7
    s_add_u32 s74, s74, s59
    s_lshr_b32 s75, s3, 1
    s_lshl_b32 s75, s75, 6
    s_add_u32 s74, s74, s75
    s_lshl_b32 s75, s3, 7
    s_add_u32 s75, s75, 159488
    s_cmp_lg_u32 s33, 0
    s_cbranch_scc1 L_ch1_fs
    s_sleep 18
L_ch1_fs:
    s_mov_b32 s68, 0
Lpoll_67:
    v_and_b32 v20, 60, v21
    buffer_load_dword v20, v20, s[16:19], s74 offen sc1
    buffer_load_dword v4, v21, s[16:19], s70 offen offset:0 sc1
    buffer_load_dword v5, v21, s[16:19], s70 offen offset:1024 sc1
    buffer_load_dword v6, v21, s[16:19], s70 offen offset:2048 sc1
    buffer_load_dword v7, v21, s[16:19], s70 offen offset:3072 sc1
    buffer_load_dword v8, v21, s[16:19], s71 offen offset:0 sc1
    buffer_load_dword v9, v21, s[16:19], s71 offen offset:1024 sc1
    buffer_load_dword v10, v21, s[16:19], s71 offen offset:2048 sc1
    buffer_load_dword v11, v21, s[16:19], s71 offen offset:3072 sc1
    buffer_load_dword v12, v21, s[16:19], s72 offen offset:0 sc1
    buffer_load_dword v13, v21, s[16:19], s72 offen offset:1024 sc1
    buffer_load_dword v14, v21, s[16:19], s72 offen offset:2048 sc1
    buffer_load_dword v15, v21, s[16:19], s72 offen offset:3072 sc1
    buffer_load_dword v16, v21, s[16:19], s73 offen offset:0 sc1
    buffer_load_dword v17, v21, s[16:19], s73 offen offset:1024 sc1
    buffer_load_dword v18, v21, s[16:19], s73 offen offset:2048 sc1
    buffer_load_dword v19, v21, s[16:19], s73 offen offset:3072 sc1
    s_cmp_lt_u32 s82, 16
    s_cbranch_scc1 Lt_70
    s_waitcnt vmcnt(0)
Ltb_71:
    v_max3_u32 v22, v4, v5, v6
    v_max3_u32 v22, v22, v7, v8
    v_max3_u32 v22, v22, v9, v10
    v_max3_u32 v22, v22, v11, v12
    v_max3_u32 v22, v22, v13, v14
    v_max3_u32 v22, v22, v15, v16
    v_max3_u32 v22, v22, v17, v18
    v_max3_u32 v22, v22, v19, v20
    v_cmp_eq_u32 vcc, -1, v22
    s_cbranch_vccnz Lpr_69
Lpd_68:
    v_max_f32_dpp v22, v20, v20 quad_perm:[1,0,3,2] row_mask:0xf bank_mask:0xf
    s_nop 1
    v_max_f32_dpp v22, v22, v22 quad_perm:[2,3,0,1] row_mask:0xf bank_mask:0xf
    s_nop 1
    v_max_f32_dpp v22, v22, v22 row_half_mirror row_mask:0xf bank_mask:0xf
    s_nop 1
    v_max_f32_dpp v22, v22, v22 row_mirror row_mask:0xf bank_mask:0xf
    v_sub_f32 v20, v20, v22
    v_exp_f32 v20, v20
    s_nop 1
    v_mul_f32_dpp v21, v20, v4 row_newbcast:0 row_mask:0xf bank_mask:0xf
    v_add_f32_dpp v22, v20, v20 quad_perm:[1,0,3,2] row_mask:0xf bank_mask:0xf
    v_fmac_f32_dpp v21, v20, v5 row_newbcast:1 row_mask:0xf bank_mask:0xf
    v_fmac_f32_dpp v21, v20, v6 row_newbcast:2 row_mask:0xf bank_mask:0xf
    v_add_f32_dpp v22, v22, v22 quad_perm:[2,3,0,1] row_mask:0xf bank_mask:0xf
    v_fmac_f32_dpp v21, v20, v7 row_newbcast:3 row_mask:0xf bank_mask:0xf
    v_fmac_f32_dpp v21, v20, v8 row_newbcast:4 row_mask:0xf bank_mask:0xf
    v_add_f32_dpp v22, v22, v22 row_half_mirror row_mask:0xf bank_mask:0xf
    ds_read_b64_tr_b16 v[4:5], v23 offset:28672
    ds_read_b64_tr_b16 v[6:7], v23 offset:29184
    v_fmac_f32_dpp v21, v20, v9 row_newbcast:5 row_mask:0xf bank_mask:0xf
    v_fmac_f32_dpp v21, v20, v10 row_newbcast:6 row_mask:0xf bank_mask:0xf
    v_add_f32_dpp v22, v22, v22 row_mirror row_mask:0xf bank_mask:0xf
    v_fmac_f32_dpp v21, v20, v11 row_newbcast:7 row_mask:0xf bank_mask:0xf
    v_fmac_f32_dpp v21, v20, v12 row_newbcast:8 row_mask:0xf bank_mask:0xf
    v_rcp_f32 v22, v22
    v_fmac_f32_dpp v21, v20, v13 row_newbcast:9 row_mask:0xf bank_mask:0xf
    v_lshl_add_u32 v23, v0, 1, s75
    v_fmac_f32_dpp v21, v20, v14 row_newbcast:10 row_mask:0xf bank_mask:0xf
    v_fmac_f32_dpp v21, v20, v15 row_newbcast:11 row_mask:0xf bank_mask:0xf
    v_fmac_f32_dpp v21, v20, v16 row_newbcast:12 row_mask:0xf bank_mask:0xf
    v_fmac_f32_dpp v21, v20, v17 row_newbcast:13 row_mask:0xf bank_mask:0xf
    v_fmac_f32_dpp v21, v20, v18 row_newbcast:14 row_mask:0xf bank_mask:0xf
    v_fmac_f32_dpp v21, v20, v19 row_newbcast:15 row_mask:0xf bank_mask:0xf
    v_mul_f32 v21, v21, v22
    v_cvt_pk_bf16_f32 v21, v21, v21
    ds_write_b16 v23, v21
    v_and_b32 v0, 48, v0
    v_add_u32 v0, 159488, v0
    s_lshl_b32 s70, s7, 8
    s_add_u32 s70, s70, s60
    s_lshl_b32 s71, s3, 6
    s_add_u32 s74, s70, s71
    s_mul_i32 s70, s3, 9216
    s_add_u32 s70, s70, s60
    s_add_u32 s71, s70, 2304
    s_add_u32 s72, s70, 4608
    s_add_u32 s73, s70, 6912
    s_waitcnt lgkmcnt(0)
    s_barrier
    ds_read_b128 v[8:11], v0 offset:448
    ds_read_b128 v[12:15], v0 offset:0
    ds_read_b128 v[16:19], v0 offset:64
    s_waitcnt lgkmcnt(2)
    v_mfma_f32_16x16x32_bf16 v[20:23], v[8:11], v[4:7], 0
    ds_read_b128 v[4:7], v0 offset:128
    ds_read_b128 v[8:11], v0 offset:192
    s_waitcnt lgkmcnt(3)
    v_mfma_f32_16x16x32_bf16 v[20:23], v[12:15], v[24:27], v[20:23]
    ds_read_b128 v[24:27], v0 offset:256
    ds_read_b128 v[12:15], v0 offset:320
    s_waitcnt lgkmcnt(4)
    v_mfma_f32_16x16x32_bf16 v[20:23], v[16:19], v[28:31], v[20:23]
    ds_read_b128 v[28:31], v0 offset:384
    s_waitcnt lgkmcnt(4)
    v_mfma_f32_16x16x32_bf16 v[20:23], v[4:7], v[32:35], v[20:23]
    s_waitcnt lgkmcnt(3)
    v_mfma_f32_16x16x32_bf16 v[20:23], v[8:11], v[36:39], v[20:23]
    s_waitcnt lgkmcnt(2)
    v_mfma_f32_16x16x32_bf16 v[20:23], v[24:27], v[40:43], v[20:23]
    s_waitcnt lgkmcnt(1)
    v_mfma_f32_16x16x32_bf16 v[20:23], v[12:15], v[44:47], v[20:23]
    s_waitcnt lgkmcnt(0)
    v_mfma_f32_16x16x32_bf16 v[20:23], v[28:31], v[48:51], v[20:23]
    v_lshrrev_b32 v0, 4, v2
    v_lshlrev_b32 v49, 2, v0
    s_mul_i32 s75, s3, 2304
    s_add_u32 s75, s75, 151040
    v_add_u32 v51, s75, v2
    s_mov_b64 exec, 0xffff
    s_nop 1
    buffer_store_dword v20, v49, s[16:19], s74 offen sc1
    s_mov_b64 exec, -1
    s_cmp_eq_u32 s63, 2
    s_cbranch_scc1 L_ch1_ret
L_ch1_b:
    s_cmp_lt_u32 s82, 16
    s_cbranch_scc1 Lt_72
Ltb_73:
    s_mov_b32 s68, 0
    s_sleep 14
Lpoll_74:
    buffer_load_dwordx4 v[4:7], v2, s[16:19], s70 offen sc1
    buffer_load_dwordx4 v[8:11], v2, s[16:19], s70 offen offset:1024 sc1
    buffer_load_dword v36, v49, s[16:19], s70 offen offset:2048 sc1
    buffer_load_dwordx4 v[12:15], v2, s[16:19], s71 offen sc1
    buffer_load_dwordx4 v[16:19], v2, s[16:19], s71 offen offset:1024 sc1
    buffer_load_dword v37, v49, s[16:19], s71 offen offset:2048 sc1
    buffer_load_dwordx4 v[20:23], v2, s[16:19], s72 offen sc1
    buffer_load_dwordx4 v[24:27], v2, s[16:19], s72 offen offset:1024 sc1
    buffer_load_dword v38, v49, s[16:19], s72 offen offset:2048 sc1
    buffer_load_dwordx4 v[28:31], v2, s[16:19], s73 offen sc1
    buffer_load_dwordx4 v[32:35], v2, s[16:19], s73 offen offset:1024 sc1
    buffer_load_dword v39, v49, s[16:19], s73 offen offset:2048 sc1
    s_cmp_lt_u32 s82, 16
    s_cbranch_scc1 Lt_77
    s_waitcnt vmcnt(0)
Ltb_78:
    v_pk_add_f32 v[40:41], v[4:5], v[12:13]
    v_pk_add_f32 v[42:43], v[6:7], v[14:15]
    v_pk_add_f32 v[44:45], v[8:9], v[16:17]
    v_pk_add_f32 v[46:47], v[10:11], v[18:19]
    v_add_f32 v48, v36, v37
    v_pk_add_f32 v[40:41], v[40:41], v[20:21]
    v_pk_add_f32 v[42:43], v[42:43], v[22:23]
    v_pk_add_f32 v[44:45], v[44:45], v[24:25]
    v_pk_add_f32 v[46:47], v[46:47], v[26:27]
    v_add_f32 v48, v48, v38
    v_pk_add_f32 v[40:41], v[40:41], v[28:29]
    v_pk_add_f32 v[42:43], v[42:43], v[30:31]
    v_pk_add_f32 v[44:45], v[44:45], v[32:33]
    v_pk_add_f32 v[46:47], v[46:47], v[34:35]
    v_add_f32 v48, v48, v39
    v_add_u32 v50, s75, v49
    ds_write_b128 v51, v[40:43]
    ds_write_b128 v51, v[44:47] offset:1024
    ds_write_b32 v50, v48 offset:2048
    v_max_u32 v50, v4, v5
    v_max3_u32 v50, v50, v6, v7
    v_max3_u32 v50, v50, v8, v9
    v_max3_u32 v50, v50, v10, v11
    v_max3_u32 v50, v50, v12, v13
    v_max3_u32 v50, v50, v14, v15
    v_max3_u32 v50, v50, v16, v17
    v_max3_u32 v50, v50, v18, v19
    v_max3_u32 v50, v50, v20, v21
    v_max3_u32 v50, v50, v22, v23
    v_max3_u32 v50, v50, v24, v25
    v_max3_u32 v50, v50, v26, v27
    v_max3_u32 v50, v50, v28, v29
    v_max3_u32 v50, v50, v30, v31
    v_max3_u32 v50, v50, v32, v33
    v_max3_u32 v50, v50, v34, v35
    v_max3_u32 v50, v50, v36, v37
    v_max3_u32 v50, v50, v38, v39
    v_cmp_eq_u32 vcc, -1, v50
    s_cbranch_vccnz Lpr_76
Lpd_75:
    v_add_u32 v14, s64, v2
    v_add_u32 v15, s64, v49
    ds_read_b128 v[4:7], v14
    ds_read_b128 v[8:11], v14 offset:1024
    ds_read_b32 v12, v15 offset:2048
    v_add_u32 v14, 151040, v2
    v_add_u32 v15, 153088, v49
    s_waitcnt lgkmcnt(3)
    s_barrier
    ds_read_b128 v[16:19], v14 offset:0
    ds_read_b128 v[20:23], v14 offset:1024
    ds_read2st64_b32 v[48:49], v15 offset0:0 offset1:9
    ds_read2st64_b32 v[50:51], v15 offset0:18 offset1:27
    ds_read_b128 v[24:27], v14 offset:2304
    ds_read_b128 v[28:31], v14 offset:3328
    ds_read_b128 v[32:35], v14 offset:4608
    ds_read_b128 v[36:39], v14 offset:5632
    ds_read_b128 v[40:43], v14 offset:6912
    ds_read_b128 v[44:47], v14 offset:7936
    v_lshlrev_b32 v13, 3, v0
    v_add_u32 v13, 162304, v13
    v_lshlrev_b32 v14, 1, v0
    v_add_u32 v14, 163328, v14
    v_and_b32 v15, 3, v0
    s_lshl_b32 s70, s7, 3
    s_add_u32 s70, s70, 162304
    v_lshl_add_u32 v15, v15, 1, s70
    s_lshl_b32 s70, s3, 8
    s_add_u32 s70, s70, s56
    s_waitcnt lgkmcnt(6)
    v_pk_add_f32 v[4:5], v[4:5], v[16:17]
    v_pk_add_f32 v[6:7], v[6:7], v[18:19]
    v_pk_add_f32 v[8:9], v[8:9], v[20:21]
    v_pk_add_f32 v[10:11], v[10:11], v[22:23]
    v_add_f32 v12, v12, v48
    s_waitcnt lgkmcnt(4)
    v_pk_add_f32 v[4:5], v[4:5], v[24:25]
    v_pk_add_f32 v[6:7], v[6:7], v[26:27]
    v_pk_add_f32 v[8:9], v[8:9], v[28:29]
    v_pk_add_f32 v[10:11], v[10:11], v[30:31]
    v_add_f32 v12, v12, v49
    s_waitcnt lgkmcnt(2)
    v_pk_add_f32 v[4:5], v[4:5], v[32:33]
    v_pk_add_f32 v[6:7], v[6:7], v[34:35]
    v_pk_add_f32 v[8:9], v[8:9], v[36:37]
    v_pk_add_f32 v[10:11], v[10:11], v[38:39]
    v_add_f32 v12, v12, v50
    s_waitcnt lgkmcnt(0)
    v_pk_add_f32 v[4:5], v[4:5], v[40:41]
    v_pk_add_f32 v[6:7], v[6:7], v[42:43]
    v_pk_add_f32 v[8:9], v[8:9], v[44:45]
    v_pk_add_f32 v[10:11], v[10:11], v[46:47]
    v_add_f32 v12, v12, v51
    v_cvt_pk_bf16_f32 v16, v4, v5
    v_cvt_pk_bf16_f32 v17, v6, v7
    v_cvt_pk_bf16_f32 v18, v8, v9
    v_cvt_pk_bf16_f32 v19, v10, v11
    v_cvt_pk_bf16_f32 v20, v12, 0
    ds_write_b64 v13, v[16:17]
    ds_write_b64 v13, v[18:19] offset:512
    ds_write_b16 v14, v20
    ds_read_u16 v27, v15
    v_lshl_add_u32 v26, v0, 2, s70
    v_dot2_f32_bf16 v4, v16, s67, 0
    v_dot2_f32_bf16 v5, v16, v16, 0
    v_dot2_f32_bf16 v4, v17, s67, v4
    v_dot2_f32_bf16 v5, v17, v17, v5
    v_dot2_f32_bf16 v4, v18, s67, v4
    v_dot2_f32_bf16 v5, v18, v18, v5
    v_dot2_f32_bf16 v4, v19, s67, v4
    v_dot2_f32_bf16 v5, v19, v19, v5
    v_dot2_f32_bf16 v4, v20, s67, v4
    v_dot2_f32_bf16 v5, v20, v20, v5
    ds_read2st64_b32 v[28:29], v26 offset0:0 offset1:36
    ds_read2st64_b32 v[44:45], v26 offset0:72 offset1:76
    v_add_f32_dpp v4, v4, v4 quad_perm:[1,0,3,2] row_mask:0xf bank_mask:0xf
    v_add_f32_dpp v5, v5, v5 quad_perm:[1,0,3,2] row_mask:0xf bank_mask:0xf
    ds_read2st64_b32 v[30:31], v26 offset0:4 offset1:40
    ds_read2st64_b32 v[32:33], v26 offset0:8 offset1:44
    v_add_f32_dpp v4, v4, v4 quad_perm:[2,3,0,1] row_mask:0xf bank_mask:0xf
    v_add_f32_dpp v5, v5, v5 quad_perm:[2,3,0,1] row_mask:0xf bank_mask:0xf
    ds_read2st64_b32 v[34:35], v26 offset0:12 offset1:48
    ds_read2st64_b32 v[36:37], v26 offset0:16 offset1:52
    v_add_f32_dpp v4, v4, v4 row_half_mirror row_mask:0xf bank_mask:0xf
    v_add_f32_dpp v5, v5, v5 row_half_mirror row_mask:0xf bank_mask:0xf
    ds_read2st64_b32 v[38:39], v26 offset0:20 offset1:56
    ds_read2st64_b32 v[40:41], v26 offset0:24 offset1:60
    v_add_f32_dpp v4, v4, v4 row_mirror row_mask:0xf bank_mask:0xf
    v_add_f32_dpp v5, v5, v5 row_mirror row_mask:0xf bank_mask:0xf
    ds_read2st64_b32 v[42:43], v26 offset0:28 offset1:64
    ds_read2st64_b32 v[46:47], v26 offset0:80 offset1:84
    v_add_f32_dpp v4, v4, v4 row_bcast:15 row_mask:0xa bank_mask:0xf
    v_add_f32_dpp v5, v5, v5 row_bcast:15 row_mask:0xa bank_mask:0xf
    ds_read2st64_b32 v[48:49], v26 offset0:88 offset1:92
    ds_read2st64_b32 v[50:51], v26 offset0:96 offset1:100
    v_add_f32_dpp v4, v4, v4 row_bcast:31 row_mask:0xc bank_mask:0xf
    v_add_f32_dpp v5, v5, v5 row_bcast:31 row_mask:0xc bank_mask:0xf
    v_mul_f32 v4, 0x3ae38e39, v4
    v_mul_f32 v5, 0x3ae38e39, v5
    v_fma_f32 v5, -v4, v4, v5
    v_max_f32 v5, 0, v5
    v_cvt_pk_bf16_f32 v8, v4, v5
    v_and_b32 v7, 0xffff0000, v8
    v_lshlrev_b32 v6, 16, v8
    v_add_f32 v7, 0x3727c5ac, v7
    v_cvt_pk_bf16_f32 v8, v7, v7
    v_lshlrev_b32 v7, 16, v8
    v_sqrt_f32 v7, v7
    s_nop 0
    v_cvt_pk_bf16_f32 v8, v7, v7
    v_lshlrev_b32 v7, 16, v8
    v_rcp_f32 v7, v7
    s_waitcnt lgkmcnt(12)
    v_lshlrev_b32 v27, 16, v27
    v_sub_f32 v9, v27, v6
    v_sub_f32 v4, v4, v6
    v_mul_f32 v5, v5, v7
    v_mul_f32 v4, v4, v7
    v_mul_f32 v5, v5, v7
    v_cvt_pk_bf16_f32 v10, v9, v9
    v_lshlrev_b32 v9, 16, v10
    v_mul_f32 v9, v9, v7
    v_cvt_pk_bf16_f32 v10, v9, v9
    v_lshlrev_b32 v9, 16, v10
    v_cvt_pk_bf16_f32 v8, v4, v5
    v_and_b32 v7, 0xffff0000, v8
    v_lshlrev_b32 v6, 16, v8
    v_add_f32 v7, 0x3727c5ac, v7
    v_cvt_pk_bf16_f32 v8, v7, v7
    v_lshlrev_b32 v7, 16, v8
    v_sqrt_f32 v7, v7
    s_nop 0
    v_cvt_pk_bf16_f32 v8, v7, v7
    v_lshlrev_b32 v7, 16, v8
    v_rcp_f32 v7, v7
    v_sub_f32 v9, v9, v6
    v_cvt_pk_bf16_f32 v10, v9, v9
    v_lshlrev_b32 v9, 16, v10
    v_mul_f32 v9, v9, v7
    v_cvt_pk_bf16_f32 v10, v9, v9
    v_lshlrev_b32 v9, 16, v10
    v_mul_f32 v9, 0x3eeff558, v9
    v_mov_b32 v25, v26
    v_readlane_b32 s70, v9, 60
    v_readlane_b32 s72, v9, 61
    v_readlane_b32 s74, v9, 62
    v_readlane_b32 s76, v9, 63
    s_cmp_lt_u32 s82, 16
    s_cbranch_scc1 Lt_79
Ltb_80:
    v_mov_b32 v26, 0x409d30fc
    s_mov_b32 s66, 0x3eeff558
    s_waitcnt lgkmcnt(0)
    v_lshlrev_b32 v12, 16, v28
    v_and_b32 v13, 0xffff0000, v28
    v_lshlrev_b32 v14, 16, v29
    v_and_b32 v15, 0xffff0000, v29
    v_lshlrev_b32 v16, 16, v44
    v_and_b32 v17, 0xffff0000, v44
    v_pk_mul_f32 v[14:15], v[14:15], s[66:67] op_sel_hi:[1,0]
    ds_read2st64_b32 v[28:29], v25 offset0:32 offset1:68
    ds_read_b32 v44, v25 offset:26624
    v_pk_fma_f32 v[18:19], v[12:13], s[70:71], v[14:15] op_sel_hi:[1,0,1]
    v_pk_fma_f32 v[22:23], v[12:13], s[72:73], v[14:15] op_sel_hi:[1,0,1]
    v_pk_fma_f32 v[20:21], v[18:19], v[18:19], v[26:27] op_sel_hi:[1,1,0]
    v_pk_fma_f32 v[24:25], v[22:23], v[22:23], v[26:27] op_sel_hi:[1,1,0]
    v_pk_mul_f32 v[20:21], v[18:19], v[20:21]
    v_pk_mul_f32 v[24:25], v[22:23], v[24:25]
    v_exp_f32 v20, -v20
    v_exp_f32 v21, -v21
    v_exp_f32 v24, -v24
    v_exp_f32 v25, -v25
    v_pk_mul_f32 v[18:19], v[18:19], v[16:17]
    v_pk_mul_f32 v[22:23], v[22:23], v[16:17]
    v_pk_add_f32 v[20:21], v[20:21], 1.0 op_sel_hi:[1,0]
    v_pk_add_f32 v[24:25], v[24:25], 1.0 op_sel_hi:[1,0]
    v_rcp_f32 v20, v20
    v_rcp_f32 v21, v21
    v_rcp_f32 v24, v24
    v_rcp_f32 v25, v25
    v_pk_mul_f32 v[4:5], v[18:19], v[20:21]
    v_pk_mul_f32 v[6:7], v[22:23], v[24:25]
    v_pk_fma_f32 v[18:19], v[12:13], s[74:75], v[14:15] op_sel_hi:[1,0,1]
    v_pk_fma_f32 v[22:23], v[12:13], s[76:77], v[14:15] op_sel_hi:[1,0,1]
    v_pk_fma_f32 v[20:21], v[18:19], v[18:19], v[26:27] op_sel_hi:[1,1,0]
    v_pk_fma_f32 v[24:25], v[22:23], v[22:23], v[26:27] op_sel_hi:[1,1,0]
    v_pk_mul_f32 v[20:21], v[18:19], v[20:21]
    v_pk_mul_f32 v[24:25], v[22:23], v[24:25]
    v_exp_f32 v20, -v20
    v_exp_f32 v21, -v21
    v_exp_f32 v24, -v24
    v_exp_f32 v25, -v25
    v_pk_mul_f32 v[18:19], v[18:19], v[16:17]
    v_pk_mul_f32 v[22:23], v[22:23], v[16:17]
    v_pk_add_f32 v[20:21], v[20:21], 1.0 op_sel_hi:[1,0]
    v_pk_add_f32 v[24:25], v[24:25], 1.0 op_sel_hi:[1,0]
    v_rcp_f32 v20, v20
    v_rcp_f32 v21, v21
    v_rcp_f32 v24, v24
    v_rcp_f32 v25, v25
    v_pk_mul_f32 v[8:9], v[18:19], v[20:21]
    v_pk_mul_f32 v[10:11], v[22:23], v[24:25]
    v_lshlrev_b32 v12, 16, v30
    v_and_b32 v13, 0xffff0000, v30
    v_lshlrev_b32 v14, 16, v31
    v_and_b32 v15, 0xffff0000, v31
    v_lshlrev_b32 v16, 16, v45
    v_and_b32 v17, 0xffff0000, v45
    v_pk_mul_f32 v[14:15], v[14:15], s[66:67] op_sel_hi:[1,0]
    v_pk_fma_f32 v[18:19], v[12:13], s[70:71], v[14:15] op_sel_hi:[1,0,1]
    v_pk_fma_f32 v[22:23], v[12:13], s[72:73], v[14:15] op_sel_hi:[1,0,1]
    v_pk_fma_f32 v[20:21], v[18:19], v[18:19], v[26:27] op_sel_hi:[1,1,0]
    v_pk_fma_f32 v[24:25], v[22:23], v[22:23], v[26:27] op_sel_hi:[1,1,0]
    v_pk_mul_f32 v[20:21], v[18:19], v[20:21]
    v_pk_mul_f32 v[24:25], v[22:23], v[24:25]
    v_exp_f32 v20, -v20
    v_exp_f32 v21, -v21
    v_exp_f32 v24, -v24
    v_exp_f32 v25, -v25
    v_pk_mul_f32 v[18:19], v[18:19], v[16:17]
    v_pk_mul_f32 v[22:23], v[22:23], v[16:17]
    v_pk_add_f32 v[20:21], v[20:21], 1.0 op_sel_hi:[1,0]
    v_pk_add_f32 v[24:25], v[24:25], 1.0 op_sel_hi:[1,0]
    v_rcp_f32 v20, v20
    v_rcp_f32 v21, v21
    v_rcp_f32 v24, v24
    v_rcp_f32 v25, v25
    v_pk_fma_f32 v[4:5], v[18:19], v[20:21], v[4:5]
    v_pk_fma_f32 v[6:7], v[22:23], v[24:25], v[6:7]
    v_pk_fma_f32 v[18:19], v[12:13], s[74:75], v[14:15] op_sel_hi:[1,0,1]
    v_pk_fma_f32 v[22:23], v[12:13], s[76:77], v[14:15] op_sel_hi:[1,0,1]
    v_pk_fma_f32 v[20:21], v[18:19], v[18:19], v[26:27] op_sel_hi:[1,1,0]
    v_pk_fma_f32 v[24:25], v[22:23], v[22:23], v[26:27] op_sel_hi:[1,1,0]
    v_pk_mul_f32 v[20:21], v[18:19], v[20:21]
    v_pk_mul_f32 v[24:25], v[22:23], v[24:25]
    v_exp_f32 v20, -v20
    v_exp_f32 v21, -v21
    v_exp_f32 v24, -v24
    v_exp_f32 v25, -v25
    v_pk_mul_f32 v[18:19], v[18:19], v[16:17]
    v_pk_mul_f32 v[22:23], v[22:23], v[16:17]
    v_pk_add_f32 v[20:21], v[20:21], 1.0 op_sel_hi:[1,0]
    v_pk_add_f32 v[24:25], v[24:25], 1.0 op_sel_hi:[1,0]
    v_rcp_f32 v20, v20
    v_rcp_f32 v21, v21
    v_rcp_f32 v24, v24
    v_rcp_f32 v25, v25
    v_pk_fma_f32 v[8:9], v[18:19], v[20:21], v[8:9]
    v_pk_fma_f32 v[10:11], v[22:23], v[24:25], v[10:11]
    v_lshlrev_b32 v12, 16, v32
    v_and_b32 v13, 0xffff0000, v32
    v_lshlrev_b32 v14, 16, v33
    v_and_b32 v15, 0xffff0000, v33
    v_lshlrev_b32 v16, 16, v46
    v_and_b32 v17, 0xffff0000, v46
    v_pk_mul_f32 v[14:15], v[14:15], s[66:67] op_sel_hi:[1,0]
    v_pk_fma_f32 v[18:19], v[12:13], s[70:71], v[14:15] op_sel_hi:[1,0,1]
    v_pk_fma_f32 v[22:23], v[12:13], s[72:73], v[14:15] op_sel_hi:[1,0,1]
    v_pk_fma_f32 v[20:21], v[18:19], v[18:19], v[26:27] op_sel_hi:[1,1,0]
    v_pk_fma_f32 v[24:25], v[22:23], v[22:23], v[26:27] op_sel_hi:[1,1,0]
    v_pk_mul_f32 v[20:21], v[18:19], v[20:21]
    v_pk_mul_f32 v[24:25], v[22:23], v[24:25]
    v_exp_f32 v20, -v20
    v_exp_f32 v21, -v21
    v_exp_f32 v24, -v24
    v_exp_f32 v25, -v25
    v_pk_mul_f32 v[18:19], v[18:19], v[16:17]
    v_pk_mul_f32 v[22:23], v[22:23], v[16:17]
    v_pk_add_f32 v[20:21], v[20:21], 1.0 op_sel_hi:[1,0]
    v_pk_add_f32 v[24:25], v[24:25], 1.0 op_sel_hi:[1,0]
    v_rcp_f32 v20, v20
    v_rcp_f32 v21, v21
    v_rcp_f32 v24, v24
    v_rcp_f32 v25, v25
    v_pk_fma_f32 v[4:5], v[18:19], v[20:21], v[4:5]
    v_pk_fma_f32 v[6:7], v[22:23], v[24:25], v[6:7]
    v_pk_fma_f32 v[18:19], v[12:13], s[74:75], v[14:15] op_sel_hi:[1,0,1]
    v_pk_fma_f32 v[22:23], v[12:13], s[76:77], v[14:15] op_sel_hi:[1,0,1]
    v_pk_fma_f32 v[20:21], v[18:19], v[18:19], v[26:27] op_sel_hi:[1,1,0]
    v_pk_fma_f32 v[24:25], v[22:23], v[22:23], v[26:27] op_sel_hi:[1,1,0]
    v_pk_mul_f32 v[20:21], v[18:19], v[20:21]
    v_pk_mul_f32 v[24:25], v[22:23], v[24:25]
    v_exp_f32 v20, -v20
    v_exp_f32 v21, -v21
    v_exp_f32 v24, -v24
    v_exp_f32 v25, -v25
    v_pk_mul_f32 v[18:19], v[18:19], v[16:17]
    v_pk_mul_f32 v[22:23], v[22:23], v[16:17]
    v_pk_add_f32 v[20:21], v[20:21], 1.0 op_sel_hi:[1,0]
    v_pk_add_f32 v[24:25], v[24:25], 1.0 op_sel_hi:[1,0]
    v_rcp_f32 v20, v20
    v_rcp_f32 v21, v21
    v_rcp_f32 v24, v24
    v_rcp_f32 v25, v25
    v_pk_fma_f32 v[8:9], v[18:19], v[20:21], v[8:9]
    v_pk_fma_f32 v[10:11], v[22:23], v[24:25], v[10:11]
    v_lshlrev_b32 v12, 16, v34
    v_and_b32 v13, 0xffff0000, v34
    v_lshlrev_b32 v14, 16, v35
    v_and_b32 v15, 0xffff0000, v35
    v_lshlrev_b32 v16, 16, v47
    v_and_b32 v17, 0xffff0000, v47
    v_pk_mul_f32 v[14:15], v[14:15], s[66:67] op_sel_hi:[1,0]
    v_pk_fma_f32 v[18:19], v[12:13], s[70:71], v[14:15] op_sel_hi:[1,0,1]
    v_pk_fma_f32 v[22:23], v[12:13], s[72:73], v[14:15] op_sel_hi:[1,0,1]
    v_pk_fma_f32 v[20:21], v[18:19], v[18:19], v[26:27] op_sel_hi:[1,1,0]
    v_pk_fma_f32 v[24:25], v[22:23], v[22:23], v[26:27] op_sel_hi:[1,1,0]
    v_pk_mul_f32 v[20:21], v[18:19], v[20:21]
    v_pk_mul_f32 v[24:25], v[22:23], v[24:25]
    v_exp_f32 v20, -v20
    v_exp_f32 v21, -v21
    v_exp_f32 v24, -v24
    v_exp_f32 v25, -v25
    v_pk_mul_f32 v[18:19], v[18:19], v[16:17]
    v_pk_mul_f32 v[22:23], v[22:23], v[16:17]
    v_pk_add_f32 v[20:21], v[20:21], 1.0 op_sel_hi:[1,0]
    v_pk_add_f32 v[24:25], v[24:25], 1.0 op_sel_hi:[1,0]
    v_rcp_f32 v20, v20
    v_rcp_f32 v21, v21
    v_rcp_f32 v24, v24
    v_rcp_f32 v25, v25
    v_pk_fma_f32 v[4:5], v[18:19], v[20:21], v[4:5]
    v_pk_fma_f32 v[6:7], v[22:23], v[24:25], v[6:7]
    v_pk_fma_f32 v[18:19], v[12:13], s[74:75], v[14:15] op_sel_hi:[1,0,1]
    v_pk_fma_f32 v[22:23], v[12:13], s[76:77], v[14:15] op_sel_hi:[1,0,1]
    v_pk_fma_f32 v[20:21], v[18:19], v[18:19], v[26:27] op_sel_hi:[1,1,0]
    v_pk_fma_f32 v[24:25], v[22:23], v[22:23], v[26:27] op_sel_hi:[1,1,0]
    v_pk_mul_f32 v[20:21], v[18:19], v[20:21]
    v_pk_mul_f32 v[24:25], v[22:23], v[24:25]
    v_exp_f32 v20, -v20
    v_exp_f32 v21, -v21
    v_exp_f32 v24, -v24
    v_exp_f32 v25, -v25
    v_pk_mul_f32 v[18:19], v[18:19], v[16:17]
    v_pk_mul_f32 v[22:23], v[22:23], v[16:17]
    v_pk_add_f32 v[20:21], v[20:21], 1.0 op_sel_hi:[1,0]
    v_pk_add_f32 v[24:25], v[24:25], 1.0 op_sel_hi:[1,0]
    v_rcp_f32 v20, v20
    v_rcp_f32 v21, v21
    v_rcp_f32 v24, v24
    v_rcp_f32 v25, v25
    v_pk_fma_f32 v[8:9], v[18:19], v[20:21], v[8:9]
    v_pk_fma_f32 v[10:11], v[22:23], v[24:25], v[10:11]
    v_lshlrev_b32 v12, 16, v36
    v_and_b32 v13, 0xffff0000, v36
    v_lshlrev_b32 v14, 16, v37
    v_and_b32 v15, 0xffff0000, v37
    v_lshlrev_b32 v16, 16, v48
    v_and_b32 v17, 0xffff0000, v48
    v_pk_mul_f32 v[14:15], v[14:15], s[66:67] op_sel_hi:[1,0]
    v_pk_fma_f32 v[18:19], v[12:13], s[70:71], v[14:15] op_sel_hi:[1,0,1]
    v_pk_fma_f32 v[22:23], v[12:13], s[72:73], v[14:15] op_sel_hi:[1,0,1]
    v_pk_fma_f32 v[20:21], v[18:19], v[18:19], v[26:27] op_sel_hi:[1,1,0]
    v_pk_fma_f32 v[24:25], v[22:23], v[22:23], v[26:27] op_sel_hi:[1,1,0]
    v_pk_mul_f32 v[20:21], v[18:19], v[20:21]
    v_pk_mul_f32 v[24:25], v[22:23], v[24:25]
    v_exp_f32 v20, -v20
    v_exp_f32 v21, -v21
    v_exp_f32 v24, -v24
    v_exp_f32 v25, -v25
    v_pk_mul_f32 v[18:19], v[18:19], v[16:17]
    v_pk_mul_f32 v[22:23], v[22:23], v[16:17]
    v_pk_add_f32 v[20:21], v[20:21], 1.0 op_sel_hi:[1,0]
    v_pk_add_f32 v[24:25], v[24:25], 1.0 op_sel_hi:[1,0]
    v_rcp_f32 v20, v20
    v_rcp_f32 v21, v21
    v_rcp_f32 v24, v24
    v_rcp_f32 v25, v25
    v_pk_fma_f32 v[4:5], v[18:19], v[20:21], v[4:5]
    v_pk_fma_f32 v[6:7], v[22:23], v[24:25], v[6:7]
    v_pk_fma_f32 v[18:19], v[12:13], s[74:75], v[14:15] op_sel_hi:[1,0,1]
    v_pk_fma_f32 v[22:23], v[12:13], s[76:77], v[14:15] op_sel_hi:[1,0,1]
    v_pk_fma_f32 v[20:21], v[18:19], v[18:19], v[26:27] op_sel_hi:[1,1,0]
    v_pk_fma_f32 v[24:25], v[22:23], v[22:23], v[26:27] op_sel_hi:[1,1,0]
    v_pk_mul_f32 v[20:21], v[18:19], v[20:21]
    v_pk_mul_f32 v[24:25], v[22:23], v[24:25]
    v_exp_f32 v20, -v20
    v_exp_f32 v21, -v21
    v_exp_f32 v24, -v24
    v_exp_f32 v25, -v25
    v_pk_mul_f32 v[18:19], v[18:19], v[16:17]
    v_pk_mul_f32 v[22:23], v[22:23], v[16:17]
    v_pk_add_f32 v[20:21], v[20:21], 1.0 op_sel_hi:[1,0]
    v_pk_add_f32 v[24:25], v[24:25], 1.0 op_sel_hi:[1,0]
    v_rcp_f32 v20, v20
    v_rcp_f32 v21, v21
    v_rcp_f32 v24, v24
    v_rcp_f32 v25, v25
    v_pk_fma_f32 v[8:9], v[18:19], v[20:21], v[8:9]
    v_pk_fma_f32 v[10:11], v[22:23], v[24:25], v[10:11]
    v_lshlrev_b32 v12, 16, v38
    v_and_b32 v13, 0xffff0000, v38
    v_lshlrev_b32 v14, 16, v39
    v_and_b32 v15, 0xffff0000, v39
    v_lshlrev_b32 v16, 16, v49
    v_and_b32 v17, 0xffff0000, v49
    v_pk_mul_f32 v[14:15], v[14:15], s[66:67] op_sel_hi:[1,0]
    v_pk_fma_f32 v[18:19], v[12:13], s[70:71], v[14:15] op_sel_hi:[1,0,1]
    v_pk_fma_f32 v[22:23], v[12:13], s[72:73], v[14:15] op_sel_hi:[1,0,1]
    v_pk_fma_f32 v[20:21], v[18:19], v[18:19], v[26:27] op_sel_hi:[1,1,0]
    v_pk_fma_f32 v[24:25], v[22:23], v[22:23], v[26:27] op_sel_hi:[1,1,0]
    v_pk_mul_f32 v[20:21], v[18:19], v[20:21]
    v_pk_mul_f32 v[24:25], v[22:23], v[24:25]
    v_exp_f32 v20, -v20
    v_exp_f32 v21, -v21
    v_exp_f32 v24, -v24
    v_exp_f32 v25, -v25
    v_pk_mul_f32 v[18:19], v[18:19], v[16:17]
    v_pk_mul_f32 v[22:23], v[22:23], v[16:17]
    v_pk_add_f32 v[20:21], v[20:21], 1.0 op_sel_hi:[1,0]
    v_pk_add_f32 v[24:25], v[24:25], 1.0 op_sel_hi:[1,0]
    v_rcp_f32 v20, v20
    v_rcp_f32 v21, v21
    v_rcp_f32 v24, v24
    v_rcp_f32 v25, v25
    v_pk_fma_f32 v[4:5], v[18:19], v[20:21], v[4:5]
    v_pk_fma_f32 v[6:7], v[22:23], v[24:25], v[6:7]
    v_pk_fma_f32 v[18:19], v[12:13], s[74:75], v[14:15] op_sel_hi:[1,0,1]
    v_pk_fma_f32 v[22:23], v[12:13], s[76:77], v[14:15] op_sel_hi:[1,0,1]
    v_pk_fma_f32 v[20:21], v[18:19], v[18:19], v[26:27] op_sel_hi:[1,1,0]
    v_pk_fma_f32 v[24:25], v[22:23], v[22:23], v[26:27] op_sel_hi:[1,1,0]
    v_pk_mul_f32 v[20:21], v[18:19], v[20:21]
    v_pk_mul_f32 v[24:25], v[22:23], v[24:25]
    v_exp_f32 v20, -v20
    v_exp_f32 v21, -v21
    v_exp_f32 v24, -v24
    v_exp_f32 v25, -v25
    v_pk_mul_f32 v[18:19], v[18:19], v[16:17]
    v_pk_mul_f32 v[22:23], v[22:23], v[16:17]
    v_pk_add_f32 v[20:21], v[20:21], 1.0 op_sel_hi:[1,0]
    v_pk_add_f32 v[24:25], v[24:25], 1.0 op_sel_hi:[1,0]
    v_rcp_f32 v20, v20
    v_rcp_f32 v21, v21
    v_rcp_f32 v24, v24
    v_rcp_f32 v25, v25
    v_pk_fma_f32 v[8:9], v[18:19], v[20:21], v[8:9]
    v_pk_fma_f32 v[10:11], v[22:23], v[24:25], v[10:11]
    v_lshlrev_b32 v12, 16, v40
    v_and_b32 v13, 0xffff0000, v40
    v_lshlrev_b32 v14, 16, v41
    v_and_b32 v15, 0xffff0000, v41
    v_lshlrev_b32 v16, 16, v50
    v_and_b32 v17, 0xffff0000, v50
    v_pk_mul_f32 v[14:15], v[14:15], s[66:67] op_sel_hi:[1,0]
    v_pk_fma_f32 v[18:19], v[12:13], s[70:71], v[14:15] op_sel_hi:[1,0,1]
    v_pk_fma_f32 v[22:23], v[12:13], s[72:73], v[14:15] op_sel_hi:[1,0,1]
    v_pk_fma_f32 v[20:21], v[18:19], v[18:19], v[26:27] op_sel_hi:[1,1,0]
    v_pk_fma_f32 v[24:25], v[22:23], v[22:23], v[26:27] op_sel_hi:[1,1,0]
    v_pk_mul_f32 v[20:21], v[18:19], v[20:21]
    v_pk_mul_f32 v[24:25], v[22:23], v[24:25]
    v_exp_f32 v20, -v20
    v_exp_f32 v21, -v21
    v_exp_f32 v24, -v24
    v_exp_f32 v25, -v25
    v_pk_mul_f32 v[18:19], v[18:19], v[16:17]
    v_pk_mul_f32 v[22:23], v[22:23], v[16:17]
    v_pk_add_f32 v[20:21], v[20:21], 1.0 op_sel_hi:[1,0]
    v_pk_add_f32 v[24:25], v[24:25], 1.0 op_sel_hi:[1,0]
    v_rcp_f32 v20, v20
    v_rcp_f32 v21, v21
    v_rcp_f32 v24, v24
    v_rcp_f32 v25, v25
    v_pk_fma_f32 v[4:5], v[18:19], v[20:21], v[4:5]
    v_pk_fma_f32 v[6:7], v[22:23], v[24:25], v[6:7]
    v_pk_fma_f32 v[18:19], v[12:13], s[74:75], v[14:15] op_sel_hi:[1,0,1]
    v_pk_fma_f32 v[22:23], v[12:13], s[76:77], v[14:15] op_sel_hi:[1,0,1]
    v_pk_fma_f32 v[20:21], v[18:19], v[18:19], v[26:27] op_sel_hi:[1,1,0]
    v_pk_fma_f32 v[24:25], v[22:23], v[22:23], v[26:27] op_sel_hi:[1,1,0]
    v_pk_mul_f32 v[20:21], v[18:19], v[20:21]
    v_pk_mul_f32 v[24:25], v[22:23], v[24:25]
    v_exp_f32 v20, -v20
    v_exp_f32 v21, -v21
    v_exp_f32 v24, -v24
    v_exp_f32 v25, -v25
    v_pk_mul_f32 v[18:19], v[18:19], v[16:17]
    v_pk_mul_f32 v[22:23], v[22:23], v[16:17]
    v_pk_add_f32 v[20:21], v[20:21], 1.0 op_sel_hi:[1,0]
    v_pk_add_f32 v[24:25], v[24:25], 1.0 op_sel_hi:[1,0]
    v_rcp_f32 v20, v20
    v_rcp_f32 v21, v21
    v_rcp_f32 v24, v24
    v_rcp_f32 v25, v25
    v_pk_fma_f32 v[8:9], v[18:19], v[20:21], v[8:9]
    v_pk_fma_f32 v[10:11], v[22:23], v[24:25], v[10:11]
    v_lshlrev_b32 v12, 16, v42
    v_and_b32 v13, 0xffff0000, v42
    v_lshlrev_b32 v14, 16, v43
    v_and_b32 v15, 0xffff0000, v43
    v_lshlrev_b32 v16, 16, v51
    v_and_b32 v17, 0xffff0000, v51
    v_pk_mul_f32 v[14:15], v[14:15], s[66:67] op_sel_hi:[1,0]
    v_pk_fma_f32 v[18:19], v[12:13], s[70:71], v[14:15] op_sel_hi:[1,0,1]
    v_pk_fma_f32 v[22:23], v[12:13], s[72:73], v[14:15] op_sel_hi:[1,0,1]
    v_pk_fma_f32 v[20:21], v[18:19], v[18:19], v[26:27] op_sel_hi:[1,1,0]
    v_pk_fma_f32 v[24:25], v[22:23], v[22:23], v[26:27] op_sel_hi:[1,1,0]
    v_pk_mul_f32 v[20:21], v[18:19], v[20:21]
    v_pk_mul_f32 v[24:25], v[22:23], v[24:25]
    v_exp_f32 v20, -v20
    v_exp_f32 v21, -v21
    v_exp_f32 v24, -v24
    v_exp_f32 v25, -v25
    v_pk_mul_f32 v[18:19], v[18:19], v[16:17]
    v_pk_mul_f32 v[22:23], v[22:23], v[16:17]
    v_pk_add_f32 v[20:21], v[20:21], 1.0 op_sel_hi:[1,0]
    v_pk_add_f32 v[24:25], v[24:25], 1.0 op_sel_hi:[1,0]
    v_rcp_f32 v20, v20
    v_rcp_f32 v21, v21
    v_rcp_f32 v24, v24
    v_rcp_f32 v25, v25
    v_pk_fma_f32 v[4:5], v[18:19], v[20:21], v[4:5]
    v_pk_fma_f32 v[6:7], v[22:23], v[24:25], v[6:7]
    v_pk_fma_f32 v[18:19], v[12:13], s[74:75], v[14:15] op_sel_hi:[1,0,1]
    v_pk_fma_f32 v[22:23], v[12:13], s[76:77], v[14:15] op_sel_hi:[1,0,1]
    v_pk_fma_f32 v[20:21], v[18:19], v[18:19], v[26:27] op_sel_hi:[1,1,0]
    v_pk_fma_f32 v[24:25], v[22:23], v[22:23], v[26:27] op_sel_hi:[1,1,0]
    v_pk_mul_f32 v[20:21], v[18:19], v[20:21]
    v_pk_mul_f32 v[24:25], v[22:23], v[24:25]
    v_exp_f32 v20, -v20
    v_exp_f32 v21, -v21
    v_exp_f32 v24, -v24
    v_exp_f32 v25, -v25
    v_pk_mul_f32 v[18:19], v[18:19], v[16:17]
    v_pk_mul_f32 v[22:23], v[22:23], v[16:17]
    v_pk_add_f32 v[20:21], v[20:21], 1.0 op_sel_hi:[1,0]
    v_pk_add_f32 v[24:25], v[24:25], 1.0 op_sel_hi:[1,0]
    v_rcp_f32 v20, v20
    v_rcp_f32 v21, v21
    v_rcp_f32 v24, v24
    v_rcp_f32 v25, v25
    v_pk_fma_f32 v[8:9], v[18:19], v[20:21], v[8:9]
    v_pk_fma_f32 v[10:11], v[22:23], v[24:25], v[10:11]
    s_waitcnt lgkmcnt(0)
    v_lshlrev_b32 v12, 16, v28
    v_and_b32 v13, 0xffff0000, v28
    v_lshlrev_b32 v14, 16, v29
    v_and_b32 v15, 0xffff0000, v29
    v_lshlrev_b32 v16, 16, v44
    v_and_b32 v17, 0xffff0000, v44
    v_pk_mul_f32 v[14:15], v[14:15], s[66:67] op_sel_hi:[1,0]
    v_pk_fma_f32 v[18:19], v[12:13], s[70:71], v[14:15] op_sel_hi:[1,0,1]
    v_pk_fma_f32 v[22:23], v[12:13], s[72:73], v[14:15] op_sel_hi:[1,0,1]
    v_pk_fma_f32 v[20:21], v[18:19], v[18:19], v[26:27] op_sel_hi:[1,1,0]
    v_pk_fma_f32 v[24:25], v[22:23], v[22:23], v[26:27] op_sel_hi:[1,1,0]
    v_pk_mul_f32 v[20:21], v[18:19], v[20:21]
    v_pk_mul_f32 v[24:25], v[22:23], v[24:25]
    v_exp_f32 v20, -v20
    v_exp_f32 v21, -v21
    v_exp_f32 v24, -v24
    v_exp_f32 v25, -v25
    v_pk_mul_f32 v[18:19], v[18:19], v[16:17]
    v_pk_mul_f32 v[22:23], v[22:23], v[16:17]
    v_pk_add_f32 v[20:21], v[20:21], 1.0 op_sel_hi:[1,0]
    v_pk_add_f32 v[24:25], v[24:25], 1.0 op_sel_hi:[1,0]
    v_rcp_f32 v20, v20
    v_rcp_f32 v21, v21
    v_rcp_f32 v24, v24
    v_rcp_f32 v25, v25
    v_pk_fma_f32 v[4:5], v[18:19], v[20:21], v[4:5]
    v_pk_fma_f32 v[6:7], v[22:23], v[24:25], v[6:7]
    v_pk_fma_f32 v[18:19], v[12:13], s[74:75], v[14:15] op_sel_hi:[1,0,1]
    v_pk_fma_f32 v[22:23], v[12:13], s[76:77], v[14:15] op_sel_hi:[1,0,1]
    v_pk_fma_f32 v[20:21], v[18:19], v[18:19], v[26:27] op_sel_hi:[1,1,0]
    v_pk_fma_f32 v[24:25], v[22:23], v[22:23], v[26:27] op_sel_hi:[1,1,0]
    v_pk_mul_f32 v[20:21], v[18:19], v[20:21]
    v_pk_mul_f32 v[24:25], v[22:23], v[24:25]
    v_exp_f32 v20, -v20
    v_exp_f32 v21, -v21
    v_exp_f32 v24, -v24
    v_exp_f32 v25, -v25
    v_pk_mul_f32 v[18:19], v[18:19], v[16:17]
    v_pk_mul_f32 v[22:23], v[22:23], v[16:17]
    v_pk_add_f32 v[20:21], v[20:21], 1.0 op_sel_hi:[1,0]
    v_pk_add_f32 v[24:25], v[24:25], 1.0 op_sel_hi:[1,0]
    v_rcp_f32 v20, v20
    v_rcp_f32 v21, v21
    v_rcp_f32 v24, v24
    v_rcp_f32 v25, v25
    v_pk_fma_f32 v[8:9], v[18:19], v[20:21], v[8:9]
    v_pk_fma_f32 v[10:11], v[22:23], v[24:25], v[10:11]
    v_add_f32 v4, v4, v5
    v_add_f32 v6, v6, v7
    v_add_f32 v8, v8, v9
    v_add_f32 v10, v10, v11
    v_lshrrev_b32 v12, 4, v0
    v_lshlrev_b32 v12, 2, v12
    s_lshl_b32 s66, s3, 4
    s_add_u32 s66, s66, 163456
    v_add_u32 v12, s66, v12
    v_add_f32_dpp v4, v4, v4 quad_perm:[1,0,3,2] row_mask:0xf bank_mask:0xf
    v_add_f32_dpp v6, v6, v6 quad_perm:[1,0,3,2] row_mask:0xf bank_mask:0xf
    v_add_f32_dpp v8, v8, v8 quad_perm:[1,0,3,2] row_mask:0xf bank_mask:0xf
    v_add_f32_dpp v10, v10, v10 quad_perm:[1,0,3,2] row_mask:0xf bank_mask:0xf
    v_add_f32_dpp v4, v4, v4 quad_perm:[2,3,0,1] row_mask:0xf bank_mask:0xf
    v_add_f32_dpp v6, v6, v6 quad_perm:[2,3,0,1] row_mask:0xf bank_mask:0xf
    v_add_f32_dpp v8, v8, v8 quad_perm:[2,3,0,1] row_mask:0xf bank_mask:0xf
    v_add_f32_dpp v10, v10, v10 quad_perm:[2,3,0,1] row_mask:0xf bank_mask:0xf
    v_add_f32_dpp v4, v4, v4 row_half_mirror row_mask:0xf bank_mask:0xf
    v_add_f32_dpp v6, v6, v6 row_half_mirror row_mask:0xf bank_mask:0xf
    v_add_f32_dpp v8, v8, v8 row_half_mirror row_mask:0xf bank_mask:0xf
    v_add_f32_dpp v10, v10, v10 row_half_mirror row_mask:0xf bank_mask:0xf
    v_add_f32_dpp v4, v4, v4 row_mirror row_mask:0xf bank_mask:0xf
    v_add_f32_dpp v6, v6, v6 row_mirror row_mask:0xf bank_mask:0xf
    v_add_f32_dpp v8, v8, v8 row_mirror row_mask:0xf bank_mask:0xf
    v_add_f32_dpp v10, v10, v10 row_mirror row_mask:0xf bank_mask:0xf
    ds_write2_b32 v12, v4, v6 offset0:0 offset1:16
    ds_write2_b32 v12, v8, v10 offset0:32 offset1:48
    v_and_b32 v13, 3, v0
    v_lshlrev_b32 v12, 6, v13
    v_add_u32 v12, 163456, v12
    s_mov_b32 s20, s52
    s_mov_b32 s21, s53
    s_mov_b32 s22, 2304
    s_lshl_b32 s66, s7, 4
    s_lshr_b32 s66, s66, s63
    s_add_u32 s66, s66, s61
    v_lshlrev_b32 v13, 2, v13
    v_lshrrev_b32 v13, s63, v13
    s_cmp_lg_u32 s3, 0
    s_waitcnt lgkmcnt(0)
    s_barrier
    s_cbranch_scc1 L_ch1_ret
    ds_read_b128 v[16:19], v12
    ds_read_b128 v[20:23], v12 offset:16
    ds_read_b128 v[28:31], v12 offset:32
    ds_read_b128 v[32:35], v12 offset:48
    s_cmp_eq_u32 s63, 1
    s_mov_b64 exec, 15
    s_waitcnt lgkmcnt(2)
    v_pk_add_f32 v[16:17], v[16:17], v[18:19]
    v_pk_add_f32 v[20:21], v[20:21], v[22:23]
    s_waitcnt lgkmcnt(0)
    v_pk_add_f32 v[28:29], v[28:29], v[30:31]
    v_pk_add_f32 v[32:33], v[32:33], v[34:35]
    v_pk_add_f32 v[16:17], v[16:17], v[20:21]
    v_pk_add_f32 v[28:29], v[28:29], v[32:33]
    v_pk_add_f32 v[16:17], v[16:17], v[28:29]
    v_add_f32 v16, v16, v17
    v_mul_f32 v16, 0x40088e99, v16
    v_cvt_pk_bf16_f32 v17, v16, v16
    v_lshlrev_b32 v16, 16, v17
    v_add_f32 v16, s78, v16
    v_cvt_pk_bf16_f32 v17, v16, v16
    v_lshlrev_b32 v16, 16, v17
    v_add_f32 v16, v16, v27
    v_cvt_pk_bf16_f32 v17, v16, v16
    v_lshlrev_b32 v16, 16, v17
    s_cbranch_scc1 L_ch1_fin
    buffer_store_dword v16, v13, s[16:19], s66 offen sc1
    s_branch L_ch1_done
L_ch1_fin:
    buffer_store_short v17, v13, s[20:23], s66 offen
L_ch1_done:
    s_mov_b64 exec, -1
L_ch1_ret:
    s_setpc_b64 s[30:31]
SUB_CH1B:
    s_mul_i32 s70, s3, 9216
    s_add_u32 s70, s70, s60
    s_add_u32 s71, s70, 2304
    s_add_u32 s72, s70, 4608
    s_add_u32 s73, s70, 6912
    v_lshlrev_b32 v49, 2, v0
    s_mul_i32 s75, s3, 2304
    s_add_u32 s75, s75, 151040
    v_add_u32 v51, s75, v2
    s_barrier
    s_branch L_ch1_b
SUB_CH2:
    v_lshrrev_b32 v13, 4, v0
    v_bfe_u32 v14, v0, 2, 2
    v_lshl_add_u32 v15, v13, 3, v14
    v_lshlrev_b32 v15, 9, v15
    v_bfe_u32 v13, v0, 2, 3
    s_lshl_b32 s70, s3, 2
    v_xor_b32 v13, s70, v13
    v_lshl_add_u32 v15, v13, 5, v15
    v_and_b32 v13, 3, v0
    v_lshl_add_u32 v15, v13, 3, v15
    v_add_u32 v15, 86016, v15
    v_xor_b32 v16, 32, v15
    v_xor_b32 v17, 64, v15
    v_xor_b32 v18, 96, v15
    ds_read_b64_tr_b16 v[20:21], v15 offset:0
    ds_read_b64_tr_b16 v[22:23], v15 offset:2048
    ds_read_b64_tr_b16 v[24:25], v15 offset:16384
    ds_read_b64_tr_b16 v[26:27], v15 offset:18432
    ds_read_b64_tr_b16 v[28:29], v16 offset:0
    ds_read_b64_tr_b16 v[30:31], v16 offset:2048
    ds_read_b64_tr_b16 v[32:33], v16 offset:16384
    ds_read_b64_tr_b16 v[34:35], v16 offset:18432
    ds_read_b64_tr_b16 v[36:37], v17 offset:0
    ds_read_b64_tr_b16 v[38:39], v17 offset:2048
    ds_read_b64_tr_b16 v[40:41], v17 offset:16384
    ds_read_b64_tr_b16 v[42:43], v17 offset:18432
    ds_read_b64_tr_b16 v[44:45], v18 offset:0
    ds_read_b64_tr_b16 v[46:47], v18 offset:2048
    ds_read_b64_tr_b16 v[48:49], v18 offset:16384
    ds_read_b64_tr_b16 v[50:51], v18 offset:18432
    v_lshlrev_b32 v19, 2, v0
    v_add_u32 v15, s64, v2
    v_add_u32 v16, s64, v19
    s_lshl_b32 s72, s5, 8
    s_lshl_b32 s74, s7, 10
    s_add_u32 s74, s74, s62
    s_lshl_b32 s71, s3, 8
    s_add_u32 s74, s74, s71
    s_cmp_eq_u32 s63, 1
    s_cbranch_scc0 L_ch2_g
    v_add_u32 v17, s72, v16
    ds_read_b128 v[4:7], v15
    ds_read_b128 v[8:11], v15 offset:1024
    ds_read_b32 v12, v16 offset:2048
    ds_read_b32 v13, v17
    s_waitcnt lgkmcnt(0)
    s_branch L_ch2_x
L_ch2_g:
    s_add_u32 s72, s72, s61
    s_lshl_b32 s73, s4, 7
    s_add_u32 s73, s73, s61
    s_add_u32 s73, s73, 0x8000
    s_mov_b32 s68, 0
    s_sleep 18
Lpoll_81:
    buffer_load_dwordx4 v[4:7], v2, s[16:19], s61 offen sc1
    buffer_load_dwordx4 v[8:11], v2, s[16:19], s61 offen offset:1024 sc1
    buffer_load_dword v12, v19, s[16:19], s61 offen offset:2048 sc1
    buffer_load_dword v13, v19, s[16:19], s72 offen sc1
    s_cmp_lt_u32 s82, 16
    s_cbranch_scc1 Lt_84
    s_waitcnt vmcnt(0)
Ltb_85:
    v_max_u32 v14, v4, v5
    v_max3_u32 v14, v14, v6, v7
    v_max3_u32 v14, v14, v8, v9
    v_max3_u32 v14, v14, v10, v11
    v_max3_u32 v14, v14, v12, v13
    v_cmp_eq_u32 vcc, -1, v14
    s_cbranch_vccnz Lpr_83
Lpd_82:
    s_or_b32 s70, s5, s3
    s_cbranch_scc1 L_ch2_nh
    s_cmp_eq_u32 s33, 0
    s_cbranch_scc1 Lgs_86
    s_mov_b64 exec, 1
    buffer_store_dword v19, v19, s[16:19], s73 offen
    s_mov_b64 exec, -1
Lgb_87:
L_ch2_nh:
    ds_write_b128 v15, v[4:7]
    ds_write_b128 v15, v[8:11] offset:1024
    ds_write_b32 v16, v12 offset:2048
L_ch2_x:
    v_cvt_pk_bf16_f32 v14, v4, v5
    v_cvt_pk_bf16_f32 v15, v6, v7
    v_cvt_pk_bf16_f32 v16, v8, v9
    v_cvt_pk_bf16_f32 v17, v10, v11
    v_cvt_pk_bf16_f32 v18, v12, 0
    v_dot2_f32_bf16 v4, v14, s67, 0
    v_dot2_f32_bf16 v5, v14, v14, 0
    v_dot2_f32_bf16 v4, v15, s67, v4
    v_dot2_f32_bf16 v5, v15, v15, v5
    v_dot2_f32_bf16 v4, v16, s67, v4
    v_dot2_f32_bf16 v5, v16, v16, v5
    v_dot2_f32_bf16 v4, v17, s67, v4
    v_dot2_f32_bf16 v5, v17, v17, v5
    v_dot2_f32_bf16 v4, v18, s67, v4
    v_dot2_f32_bf16 v5, v18, v18, v5
    v_lshlrev_b32 v9, 1, v0
    s_nop 0
    v_add_f32_dpp v4, v4, v4 quad_perm:[1,0,3,2] row_mask:0xf bank_mask:0xf
    v_add_f32_dpp v5, v5, v5 quad_perm:[1,0,3,2] row_mask:0xf bank_mask:0xf
    v_add_u32 v9, 163456, v9
    v_add_f32_dpp v4, v4, v4 quad_perm:[2,3,0,1] row_mask:0xf bank_mask:0xf
    v_add_f32_dpp v5, v5, v5 quad_perm:[2,3,0,1] row_mask:0xf bank_mask:0xf
    v_and_b32 v12, 48, v0
    v_add_f32_dpp v4, v4, v4 row_half_mirror row_mask:0xf bank_mask:0xf
    v_add_f32_dpp v5, v5, v5 row_half_mirror row_mask:0xf bank_mask:0xf
    v_add_u32 v12, 163456, v12
    v_add_f32_dpp v4, v4, v4 row_mirror row_mask:0xf bank_mask:0xf
    v_add_f32_dpp v5, v5, v5 row_mirror row_mask:0xf bank_mask:0xf
    s_nop 0
    v_add_f32_dpp v4, v4, v4 row_bcast:15 row_mask:0xa bank_mask:0xf
    v_add_f32_dpp v5, v5, v5 row_bcast:15 row_mask:0xa bank_mask:0xf
    s_nop 0
    v_add_f32_dpp v4, v4, v4 row_bcast:31 row_mask:0xc bank_mask:0xf
    v_add_f32_dpp v5, v5, v5 row_bcast:31 row_mask:0xc bank_mask:0xf
    v_mul_f32 v4, 0x3ae38e39, v4
    v_mul_f32 v5, 0x3ae38e39, v5
    v_fma_f32 v5, -v4, v4, v5
    v_max_f32 v5, 0, v5
    v_cvt_pk_bf16_f32 v8, v4, v5
    v_and_b32 v7, 0xffff0000, v8
    v_lshlrev_b32 v6, 16, v8
    v_add_f32 v7, 0x3727c5ac, v7
    v_cvt_pk_bf16_f32 v8, v7, v7
    v_lshlrev_b32 v7, 16, v8
    v_sqrt_f32 v7, v7
    s_nop 0
    v_cvt_pk_bf16_f32 v8, v7, v7
    v_lshlrev_b32 v7, 16, v8
    v_rcp_f32 v7, v7
    v_readlane_b32 s70, v6, 63
    v_readlane_b32 s71, v7, 63
    s_nop 0
    v_subrev_f32 v13, s70, v13
    v_cvt_pk_bf16_f32 v8, v13, v13
    v_lshlrev_b32 v13, 16, v8
    v_mul_f32 v13, s71, v13
    v_cvt_pk_bf16_f32 v13, v13, v13
    ds_write_b16 v9, v13
    ds_read_b128 v[4:7], v12
    ds_read_b128 v[8:11], v12 offset:64
    s_waitcnt lgkmcnt(0)
    v_mfma_f32_16x16x32_bf16 v[12:15], v[4:7], v[20:23], 0
    v_mfma_f32_16x16x32_bf16 v[12:15], v[8:11], v[24:27], v[12:15]
    v_mfma_f32_16x16x32_bf16 v[20:23], v[4:7], v[28:31], 0
    v_mfma_f32_16x16x32_bf16 v[20:23], v[8:11], v[32:35], v[20:23]
    v_mfma_f32_16x16x32_bf16 v[28:31], v[4:7], v[36:39], 0
    v_mfma_f32_16x16x32_bf16 v[28:31], v[8:11], v[40:43], v[28:31]
    v_mfma_f32_16x16x32_bf16 v[36:39], v[4:7], v[44:47], 0
    v_mfma_f32_16x16x32_bf16 v[36:39], v[8:11], v[48:51], v[36:39]
    s_nop 3
    v_mov_b32_dpp v12, v20 quad_perm:[0,1,2,3] row_mask:0x2 bank_mask:0xf
    s_nop 0
    v_mov_b32_dpp v12, v28 quad_perm:[0,1,2,3] row_mask:0x4 bank_mask:0xf
    s_nop 0
    v_mov_b32_dpp v12, v36 quad_perm:[0,1,2,3] row_mask:0x8 bank_mask:0xf
    s_cmp_eq_u32 s33, 0
    s_cbranch_scc1 Lgs_88
    buffer_store_dword v12, v19, s[16:19], s74 offen
Lgb_89:
    s_setpc_b64 s[30:31]
SUB_RING:
    s_add_u32 s28, s27, 0
    s_add_u32 m0, s57, 10240
    s_nop 0
    buffer_load_dwordx4 v1, s[8:11], s28 offen offset:0 lds
    s_add_u32 m0, s57, 11136
    s_nop 0
    buffer_load_dwordx4 v1, s[8:11], s28 offen offset:128 lds
    s_add_u32 m0, s57, 11776
    s_nop 0
    buffer_load_dwordx4 v1, s[8:11], s28 offen offset:512 lds
    s_add_u32 m0, s57, 12672
    s_nop 0
    buffer_load_dwordx4 v1, s[8:11], s28 offen offset:640 lds
    s_add_u32 m0, s57, 13312
    s_nop 0
    buffer_load_dwordx4 v1, s[8:11], s28 offen offset:1024 lds
    s_add_u32 m0, s57, 14208
    s_nop 0
    buffer_load_dwordx4 v1, s[8:11], s28 offen offset:1152 lds
    s_add_u32 m0, s57, 14848
    s_nop 0
    buffer_load_dwordx4 v1, s[8:11], s28 offen offset:1536 lds
    s_add_u32 m0, s57, 15744
    s_nop 0
    buffer_load_dwordx4 v1, s[8:11], s28 offen offset:1664 lds
    s_add_u32 s28, s27, 8192
    s_add_u32 m0, s57, 18432
    s_nop 0
    buffer_load_dwordx4 v1, s[8:11], s28 offen offset:0 lds
    s_add_u32 m0, s57, 19328
    s_nop 0
    buffer_load_dwordx4 v1, s[8:11], s28 offen offset:128 lds
    s_add_u32 m0, s57, -512
    s_nop 0
    buffer_load_dwordx4 v1, s[8:11], s28 offen offset:512 lds
    s_add_u32 m0, s57, 384
    s_nop 0
    buffer_load_dwordx4 v1, s[8:11], s28 offen offset:640 lds
    s_add_u32 m0, s57, 1024
    s_nop 0
    buffer_load_dwordx4 v1, s[8:11], s28 offen offset:1024 lds
    s_add_u32 m0, s57, 1920
    s_nop 0
    buffer_load_dwordx4 v1, s[8:11], s28 offen offset:1152 lds
    s_add_u32 m0, s57, 2560
    s_nop 0
    buffer_load_dwordx4 v1, s[8:11], s28 offen offset:1536 lds
    s_add_u32 m0, s57, 3456
    s_nop 0
    buffer_load_dwordx4 v1, s[8:11], s28 offen offset:1664 lds
    v_bfe_u32 v15, v0, 1, 1
    v_lshlrev_b32 v12, 8, v15
    v_lshrrev_b32 v13, 4, v0
    v_lshl_add_u32 v12, v13, 5, v12
    v_and_b32 v14, 1, v0
    v_lshl_add_u32 v12, v14, 4, v12
    v_add_u32 v12, s65, v12
    v_bfe_u32 v15, v0, 4, 1
    v_lshlrev_b32 v47, 9, v15
    v_and_b32 v15, 15, v0
    v_lshl_add_u32 v47, v15, 5, v47
    v_lshrrev_b32 v15, 5, v0
    v_lshl_add_u32 v47, v15, 4, v47
    s_lshl_b32 s70, s3, 10
    s_add_u32 s70, s70, s64
    v_add_u32 v47, s70, v47
    ds_read_b128 v[4:7], v12
    ds_read_b128 v[8:11], v12 offset:128
    v_add_u32 v48, s57, v2
    s_add_u32 s28, s27, 16384
    s_add_u32 m0, s57, 6144
    s_nop 0
    buffer_load_dwordx4 v1, s[8:11], s28 offen offset:0 lds
    s_waitcnt vmcnt(16)
    ds_read_b128 v[34:37], v48 offset:10240
    s_add_u32 m0, s57, 7040
    s_nop 0
    buffer_load_dwordx4 v1, s[8:11], s28 offen offset:128 lds
    s_waitcnt vmcnt(16)
    ds_read_b128 v[38:41], v48 offset:11264
    s_add_u32 m0, s57, 7680
    s_nop 0
    buffer_load_dwordx4 v1, s[8:11], s28 offen offset:512 lds
    s_waitcnt vmcnt(16)
    ds_read_b128 v[42:45], v48 offset:12288
    s_waitcnt lgkmcnt(2)
    v_mfma_f32_16x16x32_bf16 v[12:15], v[4:7], v[34:37], 0
    s_add_u32 m0, s57, 8576
    s_nop 0
    buffer_load_dwordx4 v1, s[8:11], s28 offen offset:640 lds
    s_waitcnt vmcnt(16)
    ds_read_b128 v[34:37], v48 offset:13312
    s_waitcnt lgkmcnt(2)
    v_mfma_f32_16x16x32_bf16 v[12:15], v[8:11], v[38:41], v[12:15]
    s_add_u32 m0, s57, 9216
    s_nop 0
    buffer_load_dwordx4 v1, s[8:11], s28 offen offset:1024 lds
    s_waitcnt vmcnt(16)
    ds_read_b128 v[38:41], v48 offset:14336
    s_waitcnt lgkmcnt(2)
    v_mfma_f32_16x16x32_bf16 v[16:19], v[4:7], v[42:45], 0
    s_add_u32 m0, s57, 10112
    s_nop 0
    buffer_load_dwordx4 v1, s[8:11], s28 offen offset:1152 lds
    s_waitcnt vmcnt(16)
    ds_read_b128 v[42:45], v48 offset:15360
    s_waitcnt lgkmcnt(2)
    v_mfma_f32_16x16x32_bf16 v[16:19], v[8:11], v[34:37], v[16:19]
    s_add_u32 m0, s57, 10752
    s_nop 0
    buffer_load_dwordx4 v1, s[8:11], s28 offen offset:1536 lds
    s_waitcnt vmcnt(16)
    ds_read_b128 v[34:37], v48 offset:16384
    s_waitcnt lgkmcnt(2)
    v_mfma_f32_16x16x32_bf16 v[20:23], v[4:7], v[38:41], 0
    s_add_u32 m0, s57, 11648
    s_nop 0
    buffer_load_dwordx4 v1, s[8:11], s28 offen offset:1664 lds
    s_waitcnt vmcnt(16)
    ds_read_b128 v[38:41], v48 offset:17408
    s_waitcnt lgkmcnt(2)
    v_mfma_f32_16x16x32_bf16 v[20:23], v[8:11], v[42:45], v[20:23]
    v_add_f32_dpp v32, v13, v12 quad_perm:[1,0,3,2] row_mask:0x1 bank_mask:0xf
    v_add_f32_dpp v33, v14, v15 quad_perm:[1,0,3,2] row_mask:0x1 bank_mask:0xf
    s_add_u32 s28, s27, 24576
    s_add_u32 m0, s57, 14336
    s_nop 0
    buffer_load_dwordx4 v1, s[8:11], s28 offen offset:0 lds
    s_waitcnt vmcnt(16)
    ds_read_b128 v[42:45], v48 offset:18432
    s_waitcnt lgkmcnt(2)
    v_mfma_f32_16x16x32_bf16 v[12:15], v[4:7], v[34:37], 0
    s_add_u32 m0, s57, 15232
    s_nop 0
    buffer_load_dwordx4 v1, s[8:11], s28 offen offset:128 lds
    s_waitcnt vmcnt(16)
    ds_read_b128 v[34:37], v48 offset:19456
    s_waitcnt lgkmcnt(2)
    v_mfma_f32_16x16x32_bf16 v[12:15], v[8:11], v[38:41], v[12:15]
    v_add_f32_dpp v32, v17, v16 quad_perm:[1,0,3,2] row_mask:0x2 bank_mask:0xf
    v_add_f32_dpp v33, v18, v19 quad_perm:[1,0,3,2] row_mask:0x2 bank_mask:0xf
    s_add_u32 m0, s57, 15872
    s_nop 0
    buffer_load_dwordx4 v1, s[8:11], s28 offen offset:512 lds
    s_waitcnt vmcnt(16)
    ds_read_b128 v[38:41], v48 offset:0
    s_waitcnt lgkmcnt(2)
    v_mfma_f32_16x16x32_bf16 v[16:19], v[4:7], v[42:45], 0
    s_add_u32 m0, s57, 16768
    s_nop 0
    buffer_load_dwordx4 v1, s[8:11], s28 offen offset:640 lds
    s_waitcnt vmcnt(16)
    ds_read_b128 v[42:45], v48 offset:1024
    s_waitcnt lgkmcnt(2)
    v_mfma_f32_16x16x32_bf16 v[16:19], v[8:11], v[34:37], v[16:19]
    v_add_f32_dpp v32, v21, v20 quad_perm:[1,0,3,2] row_mask:0x4 bank_mask:0xf
    v_add_f32_dpp v33, v22, v23 quad_perm:[1,0,3,2] row_mask:0x4 bank_mask:0xf
    s_add_u32 m0, s57, 17408
    s_nop 0
    buffer_load_dwordx4 v1, s[8:11], s28 offen offset:1024 lds
    s_waitcnt vmcnt(16)
    ds_read_b128 v[34:37], v48 offset:2048
    s_waitcnt lgkmcnt(2)
    v_mfma_f32_16x16x32_bf16 v[20:23], v[4:7], v[38:41], 0
    s_add_u32 m0, s57, 18304
    s_nop 0
    buffer_load_dwordx4 v1, s[8:11], s28 offen offset:1152 lds
    s_waitcnt vmcnt(16)
    ds_read_b128 v[38:41], v48 offset:3072
    s_waitcnt lgkmcnt(2)
    v_mfma_f32_16x16x32_bf16 v[20:23], v[8:11], v[42:45], v[20:23]
    v_add_f32_dpp v32, v13, v12 quad_perm:[1,0,3,2] row_mask:0x8 bank_mask:0xf
    v_add_f32_dpp v33, v14, v15 quad_perm:[1,0,3,2] row_mask:0x8 bank_mask:0xf
    v_cndmask_b32 v24, v32, v33, s[24:25]
    s_add_u32 m0, s57, -1536
    s_nop 0
    buffer_load_dwordx4 v1, s[8:11], s28 offen offset:1536 lds
    s_waitcnt vmcnt(16)
    ds_read_b128 v[42:45], v48 offset:4096
    s_waitcnt lgkmcnt(2)
    v_mfma_f32_16x16x32_bf16 v[12:15], v[4:7], v[34:37], 0
    s_add_u32 m0, s57, -640
    s_nop 0
    buffer_load_dwordx4 v1, s[8:11], s28 offen offset:1664 lds
    s_waitcnt vmcnt(16)
    ds_read_b128 v[34:37], v48 offset:5120
    s_waitcnt lgkmcnt(2)
    v_mfma_f32_16x16x32_bf16 v[12:15], v[8:11], v[38:41], v[12:15]
    v_add_f32_dpp v32, v17, v16 quad_perm:[1,0,3,2] row_mask:0x1 bank_mask:0xf
    v_add_f32_dpp v33, v18, v19 quad_perm:[1,0,3,2] row_mask:0x1 bank_mask:0xf
    s_add_u32 s28, s27, 32768
    s_add_u32 m0, s57, 2048
    s_nop 0
    buffer_load_dwordx4 v1, s[8:11], s28 offen offset:0 lds
    s_waitcnt vmcnt(16)
    ds_read_b128 v[38:41], v48 offset:6144
    s_waitcnt lgkmcnt(2)
    v_mfma_f32_16x16x32_bf16 v[16:19], v[4:7], v[42:45], 0
    s_add_u32 m0, s57, 2944
    s_nop 0
    buffer_load_dwordx4 v1, s[8:11], s28 offen offset:128 lds
    s_waitcnt vmcnt(16)
    ds_read_b128 v[42:45], v48 offset:7168
    s_waitcnt lgkmcnt(2)
    v_mfma_f32_16x16x32_bf16 v[16:19], v[8:11], v[34:37], v[16:19]
    v_add_f32_dpp v32, v21, v20 quad_perm:[1,0,3,2] row_mask:0x2 bank_mask:0xf
    v_add_f32_dpp v33, v22, v23 quad_perm:[1,0,3,2] row_mask:0x2 bank_mask:0xf
    s_add_u32 m0, s57, 3584
    s_nop 0
    buffer_load_dwordx4 v1, s[8:11], s28 offen offset:512 lds
    s_waitcnt vmcnt(16)
    ds_read_b128 v[34:37], v48 offset:8192
    s_waitcnt lgkmcnt(2)
    v_mfma_f32_16x16x32_bf16 v[20:23], v[4:7], v[38:41], 0
    s_add_u32 m0, s57, 4480
    s_nop 0
    buffer_load_dwordx4 v1, s[8:11], s28 offen offset:640 lds
    s_waitcnt vmcnt(16)
    ds_read_b128 v[38:41], v48 offset:9216
    s_waitcnt lgkmcnt(2)
    v_mfma_f32_16x16x32_bf16 v[20:23], v[8:11], v[42:45], v[20:23]
    v_add_f32_dpp v32, v13, v12 quad_perm:[1,0,3,2] row_mask:0x4 bank_mask:0xf
    v_add_f32_dpp v33, v14, v15 quad_perm:[1,0,3,2] row_mask:0x4 bank_mask:0xf
    s_add_u32 m0, s57, 5120
    s_nop 0
    buffer_load_dwordx4 v1, s[8:11], s28 offen offset:1024 lds
    s_waitcnt vmcnt(16)
    ds_read_b128 v[42:45], v48 offset:10240
    s_waitcnt lgkmcnt(2)
    v_mfma_f32_16x16x32_bf16 v[12:15], v[4:7], v[34:37], 0
    s_add_u32 m0, s57, 6016
    s_nop 0
    buffer_load_dwordx4 v1, s[8:11], s28 offen offset:1152 lds
    s_waitcnt vmcnt(16)
    ds_read_b128 v[34:37], v48 offset:11264
    s_waitcnt lgkmcnt(2)
    v_mfma_f32_16x16x32_bf16 v[12:15], v[8:11], v[38:41], v[12:15]
    v_add_f32_dpp v32, v17, v16 quad_perm:[1,0,3,2] row_mask:0x8 bank_mask:0xf
    v_add_f32_dpp v33, v18, v19 quad_perm:[1,0,3,2] row_mask:0x8 bank_mask:0xf
    v_cndmask_b32 v25, v32, v33, s[24:25]
    v_max_f32 v46, v24, v25
    s_add_u32 m0, s57, 6656
    s_nop 0
    buffer_load_dwordx4 v1, s[8:11], s28 offen offset:1536 lds
    s_waitcnt vmcnt(16)
    ds_read_b128 v[38:41], v48 offset:12288
    s_waitcnt lgkmcnt(2)
    v_mfma_f32_16x16x32_bf16 v[16:19], v[4:7], v[42:45], 0
    s_add_u32 m0, s57, 7552
    s_nop 0
    buffer_load_dwordx4 v1, s[8:11], s28 offen offset:1664 lds
    s_waitcnt vmcnt(16)
    ds_read_b128 v[42:45], v48 offset:13312
    s_waitcnt lgkmcnt(2)
    v_mfma_f32_16x16x32_bf16 v[16:19], v[8:11], v[34:37], v[16:19]
    v_add_f32_dpp v32, v21, v20 quad_perm:[1,0,3,2] row_mask:0x1 bank_mask:0xf
    v_add_f32_dpp v33, v22, v23 quad_perm:[1,0,3,2] row_mask:0x1 bank_mask:0xf
    s_add_u32 s28, s27, 40960
    s_add_u32 m0, s57, 10240
    s_nop 0
    buffer_load_dwordx4 v1, s[8:11], s28 offen offset:0 lds
    s_waitcnt vmcnt(16)
    ds_read_b128 v[34:37], v48 offset:14336
    s_waitcnt lgkmcnt(2)
    v_mfma_f32_16x16x32_bf16 v[20:23], v[4:7], v[38:41], 0
    s_add_u32 m0, s57, 11136
    s_nop 0
    buffer_load_dwordx4 v1, s[8:11], s28 offen offset:128 lds
    s_waitcnt vmcnt(16)
    ds_read_b128 v[38:41], v48 offset:15360
    s_waitcnt lgkmcnt(2)
    v_mfma_f32_16x16x32_bf16 v[20:23], v[8:11], v[42:45], v[20:23]
    v_add_f32_dpp v32, v13, v12 quad_perm:[1,0,3,2] row_mask:0x2 bank_mask:0xf
    v_add_f32_dpp v33, v14, v15 quad_perm:[1,0,3,2] row_mask:0x2 bank_mask:0xf
    s_add_u32 m0, s57, 11776
    s_nop 0
    buffer_load_dwordx4 v1, s[8:11], s28 offen offset:512 lds
    s_waitcnt vmcnt(16)
    ds_read_b128 v[42:45], v48 offset:16384
    s_waitcnt lgkmcnt(2)
    v_mfma_f32_16x16x32_bf16 v[12:15], v[4:7], v[34:37], 0
    s_add_u32 m0, s57, 12672
    s_nop 0
    buffer_load_dwordx4 v1, s[8:11], s28 offen offset:640 lds
    s_waitcnt vmcnt(16)
    ds_read_b128 v[34:37], v48 offset:17408
    s_waitcnt lgkmcnt(2)
    v_mfma_f32_16x16x32_bf16 v[12:15], v[8:11], v[38:41], v[12:15]
    v_add_f32_dpp v32, v17, v16 quad_perm:[1,0,3,2] row_mask:0x4 bank_mask:0xf
    v_add_f32_dpp v33, v18, v19 quad_perm:[1,0,3,2] row_mask:0x4 bank_mask:0xf
    s_add_u32 m0, s57, 13312
    s_nop 0
    buffer_load_dwordx4 v1, s[8:11], s28 offen offset:1024 lds
    s_waitcnt vmcnt(16)
    ds_read_b128 v[38:41], v48 offset:18432
    s_waitcnt lgkmcnt(2)
    v_mfma_f32_16x16x32_bf16 v[16:19], v[4:7], v[42:45], 0
    s_add_u32 m0, s57, 14208
    s_nop 0
    buffer_load_dwordx4 v1, s[8:11], s28 offen offset:1152 lds
    s_waitcnt vmcnt(16)
    ds_read_b128 v[42:45], v48 offset:19456
    s_waitcnt lgkmcnt(2)
    v_mfma_f32_16x16x32_bf16 v[16:19], v[8:11], v[34:37], v[16:19]
    v_add_f32_dpp v32, v21, v20 quad_perm:[1,0,3,2] row_mask:0x8 bank_mask:0xf
    v_add_f32_dpp v33, v22, v23 quad_perm:[1,0,3,2] row_mask:0x8 bank_mask:0xf
    v_cndmask_b32 v26, v32, v33, s[24:25]
    s_add_u32 m0, s57, 14848
    s_nop 0
    buffer_load_dwordx4 v1, s[8:11], s28 offen offset:1536 lds
    s_waitcnt vmcnt(16)
    ds_read_b128 v[34:37], v48 offset:0
    s_waitcnt lgkmcnt(2)
    v_mfma_f32_16x16x32_bf16 v[20:23], v[4:7], v[38:41], 0
    s_add_u32 m0, s57, 15744
    s_nop 0
    buffer_load_dwordx4 v1, s[8:11], s28 offen offset:1664 lds
    s_waitcnt vmcnt(16)
    ds_read_b128 v[38:41], v48 offset:1024
    s_waitcnt lgkmcnt(2)
    v_mfma_f32_16x16x32_bf16 v[20:23], v[8:11], v[42:45], v[20:23]
    v_add_f32_dpp v32, v13, v12 quad_perm:[1,0,3,2] row_mask:0x1 bank_mask:0xf
    v_add_f32_dpp v33, v14, v15 quad_perm:[1,0,3,2] row_mask:0x1 bank_mask:0xf
    s_add_u32 s28, s27, 49152
    s_add_u32 m0, s57, 18432
    s_nop 0
    buffer_load_dwordx4 v1, s[8:11], s28 offen offset:0 lds
    s_waitcnt vmcnt(16)
    ds_read_b128 v[42:45], v48 offset:2048
    s_waitcnt lgkmcnt(2)
    v_mfma_f32_16x16x32_bf16 v[12:15], v[4:7], v[34:37], 0
    s_add_u32 m0, s57, 19328
    s_nop 0
    buffer_load_dwordx4 v1, s[8:11], s28 offen offset:128 lds
    s_waitcnt vmcnt(16)
    ds_read_b128 v[34:37], v48 offset:3072
    s_waitcnt lgkmcnt(2)
    v_mfma_f32_16x16x32_bf16 v[12:15], v[8:11], v[38:41], v[12:15]
    v_add_f32_dpp v32, v17, v16 quad_perm:[1,0,3,2] row_mask:0x2 bank_mask:0xf
    v_add_f32_dpp v33, v18, v19 quad_perm:[1,0,3,2] row_mask:0x2 bank_mask:0xf
    s_add_u32 m0, s57, -512
    s_nop 0
    buffer_load_dwordx4 v1, s[8:11], s28 offen offset:512 lds
    s_waitcnt vmcnt(16)
    ds_read_b128 v[38:41], v48 offset:4096
    s_waitcnt lgkmcnt(2)
    v_mfma_f32_16x16x32_bf16 v[16:19], v[4:7], v[42:45], 0
    s_add_u32 m0, s57, 384
    s_nop 0
    buffer_load_dwordx4 v1, s[8:11], s28 offen offset:640 lds
    s_waitcnt vmcnt(16)
    ds_read_b128 v[42:45], v48 offset:5120
    s_waitcnt lgkmcnt(2)
    v_mfma_f32_16x16x32_bf16 v[16:19], v[8:11], v[34:37], v[16:19]
    v_add_f32_dpp v32, v21, v20 quad_perm:[1,0,3,2] row_mask:0x4 bank_mask:0xf
    v_add_f32_dpp v33, v22, v23 quad_perm:[1,0,3,2] row_mask:0x4 bank_mask:0xf
    s_add_u32 m0, s57, 1024
    s_nop 0
    buffer_load_dwordx4 v1, s[8:11], s28 offen offset:1024 lds
    s_waitcnt vmcnt(16)
    ds_read_b128 v[34:37], v48 offset:6144
    s_waitcnt lgkmcnt(2)
    v_mfma_f32_16x16x32_bf16 v[20:23], v[4:7], v[38:41], 0
    s_add_u32 m0, s57, 1920
    s_nop 0
    buffer_load_dwordx4 v1, s[8:11], s28 offen offset:1152 lds
    s_waitcnt vmcnt(16)
    ds_read_b128 v[38:41], v48 offset:7168
    s_waitcnt lgkmcnt(2)
    v_mfma_f32_16x16x32_bf16 v[20:23], v[8:11], v[42:45], v[20:23]
    v_add_f32_dpp v32, v13, v12 quad_perm:[1,0,3,2] row_mask:0x8 bank_mask:0xf
    v_add_f32_dpp v33, v14, v15 quad_perm:[1,0,3,2] row_mask:0x8 bank_mask:0xf
    v_cndmask_b32 v27, v32, v33, s[24:25]
    v_max3_f32 v46, v46, v26, v27
    s_add_u32 m0, s57, 2560
    s_nop 0
    buffer_load_dwordx4 v1, s[8:11], s28 offen offset:1536 lds
    s_waitcnt vmcnt(16)
    ds_read_b128 v[42:45], v48 offset:8192
    s_waitcnt lgkmcnt(2)
    v_mfma_f32_16x16x32_bf16 v[12:15], v[4:7], v[34:37], 0
    s_add_u32 m0, s57, 3456
    s_nop 0
    buffer_load_dwordx4 v1, s[8:11], s28 offen offset:1664 lds
    s_waitcnt vmcnt(16)
    ds_read_b128 v[34:37], v48 offset:9216
    s_waitcnt lgkmcnt(2)
    v_mfma_f32_16x16x32_bf16 v[12:15], v[8:11], v[38:41], v[12:15]
    v_add_f32_dpp v32, v17, v16 quad_perm:[1,0,3,2] row_mask:0x1 bank_mask:0xf
    v_add_f32_dpp v33, v18, v19 quad_perm:[1,0,3,2] row_mask:0x1 bank_mask:0xf
    s_add_u32 s28, s27, 57344
    s_add_u32 m0, s57, 6144
    s_nop 0
    buffer_load_dwordx4 v1, s[8:11], s28 offen offset:0 lds
    s_waitcnt vmcnt(16)
    ds_read_b128 v[38:41], v48 offset:10240
    s_waitcnt lgkmcnt(2)
    v_mfma_f32_16x16x32_bf16 v[16:19], v[4:7], v[42:45], 0
    s_add_u32 m0, s57, 7040
    s_nop 0
    buffer_load_dwordx4 v1, s[8:11], s28 offen offset:128 lds
    s_waitcnt vmcnt(16)
    ds_read_b128 v[42:45], v48 offset:11264
    s_waitcnt lgkmcnt(2)
    v_mfma_f32_16x16x32_bf16 v[16:19], v[8:11], v[34:37], v[16:19]
    v_add_f32_dpp v32, v21, v20 quad_perm:[1,0,3,2] row_mask:0x2 bank_mask:0xf
    v_add_f32_dpp v33, v22, v23 quad_perm:[1,0,3,2] row_mask:0x2 bank_mask:0xf
    s_add_u32 m0, s57, 7680
    s_nop 0
    buffer_load_dwordx4 v1, s[8:11], s28 offen offset:512 lds
    s_waitcnt vmcnt(16)
    ds_read_b128 v[34:37], v48 offset:12288
    s_waitcnt lgkmcnt(2)
    v_mfma_f32_16x16x32_bf16 v[20:23], v[4:7], v[38:41], 0
    s_add_u32 m0, s57, 8576
    s_nop 0
    buffer_load_dwordx4 v1, s[8:11], s28 offen offset:640 lds
    s_waitcnt vmcnt(16)
    ds_read_b128 v[38:41], v48 offset:13312
    s_waitcnt lgkmcnt(2)
    v_mfma_f32_16x16x32_bf16 v[20:23], v[8:11], v[42:45], v[20:23]
    v_add_f32_dpp v32, v13, v12 quad_perm:[1,0,3,2] row_mask:0x4 bank_mask:0xf
    v_add_f32_dpp v33, v14, v15 quad_perm:[1,0,3,2] row_mask:0x4 bank_mask:0xf
    s_add_u32 m0, s57, 9216
    s_nop 0
    buffer_load_dwordx4 v1, s[8:11], s28 offen offset:1024 lds
    s_waitcnt vmcnt(16)
    ds_read_b128 v[42:45], v48 offset:14336
    s_waitcnt lgkmcnt(2)
    v_mfma_f32_16x16x32_bf16 v[12:15], v[4:7], v[34:37], 0
    s_add_u32 m0, s57, 10112
    s_nop 0
    buffer_load_dwordx4 v1, s[8:11], s28 offen offset:1152 lds
    s_waitcnt vmcnt(16)
    ds_read_b128 v[34:37], v48 offset:15360
    s_waitcnt lgkmcnt(2)
    v_mfma_f32_16x16x32_bf16 v[12:15], v[8:11], v[38:41], v[12:15]
    v_add_f32_dpp v32, v17, v16 quad_perm:[1,0,3,2] row_mask:0x8 bank_mask:0xf
    v_add_f32_dpp v33, v18, v19 quad_perm:[1,0,3,2] row_mask:0x8 bank_mask:0xf
    v_cndmask_b32 v28, v32, v33, s[24:25]
    s_add_u32 m0, s57, 10752
    s_nop 0
    buffer_load_dwordx4 v1, s[8:11], s28 offen offset:1536 lds
    s_waitcnt vmcnt(16)
    ds_read_b128 v[38:41], v48 offset:16384
    s_waitcnt lgkmcnt(2)
    v_mfma_f32_16x16x32_bf16 v[16:19], v[4:7], v[42:45], 0
    s_add_u32 m0, s57, 11648
    s_nop 0
    buffer_load_dwordx4 v1, s[8:11], s28 offen offset:1664 lds
    s_waitcnt vmcnt(16)
    ds_read_b128 v[42:45], v48 offset:17408
    s_waitcnt lgkmcnt(2)
    v_mfma_f32_16x16x32_bf16 v[16:19], v[8:11], v[34:37], v[16:19]
    v_add_f32_dpp v32, v21, v20 quad_perm:[1,0,3,2] row_mask:0x1 bank_mask:0xf
    v_add_f32_dpp v33, v22, v23 quad_perm:[1,0,3,2] row_mask:0x1 bank_mask:0xf
    s_add_u32 s28, s27, 0
    s_add_u32 m0, s57, 12288
    s_nop 0
    buffer_load_dwordx4 v2, s[12:15], s28 offen offset:2048 lds
    s_waitcnt vmcnt(16)
    ds_read_b128 v[34:37], v48 offset:18432
    s_waitcnt lgkmcnt(2)
    v_mfma_f32_16x16x32_bf16 v[20:23], v[4:7], v[38:41], 0
    s_add_u32 m0, s57, 12288
    s_nop 0
    buffer_load_dwordx4 v2, s[12:15], s28 offen offset:3072 lds
    s_waitcnt vmcnt(16)
    ds_read_b128 v[38:41], v48 offset:19456
    s_waitcnt lgkmcnt(2)
    v_mfma_f32_16x16x32_bf16 v[20:23], v[8:11], v[42:45], v[20:23]
    v_add_f32_dpp v32, v13, v12 quad_perm:[1,0,3,2] row_mask:0x2 bank_mask:0xf
    v_add_f32_dpp v33, v14, v15 quad_perm:[1,0,3,2] row_mask:0x2 bank_mask:0xf
    s_add_u32 s28, s27, 4096
    s_add_u32 m0, s57, 14336
    s_nop 0
    buffer_load_dwordx4 v2, s[12:15], s28 offen offset:2048 lds
    s_waitcnt vmcnt(16)
    ds_read_b128 v[42:45], v48 offset:0
    s_waitcnt lgkmcnt(2)
    v_mfma_f32_16x16x32_bf16 v[12:15], v[4:7], v[34:37], 0
    s_add_u32 m0, s57, 14336
    s_nop 0
    buffer_load_dwordx4 v2, s[12:15], s28 offen offset:3072 lds
    s_waitcnt vmcnt(16)
    ds_read_b128 v[34:37], v48 offset:1024
    s_waitcnt lgkmcnt(2)
    v_mfma_f32_16x16x32_bf16 v[12:15], v[8:11], v[38:41], v[12:15]
    v_add_f32_dpp v32, v17, v16 quad_perm:[1,0,3,2] row_mask:0x4 bank_mask:0xf
    v_add_f32_dpp v33, v18, v19 quad_perm:[1,0,3,2] row_mask:0x4 bank_mask:0xf
    s_add_u32 s28, s27, 8192
    s_add_u32 m0, s57, 16384
    s_nop 0
    buffer_load_dwordx4 v2, s[12:15], s28 offen offset:2048 lds
    s_waitcnt vmcnt(16)
    ds_read_b128 v[38:41], v48 offset:2048
    s_waitcnt lgkmcnt(2)
    v_mfma_f32_16x16x32_bf16 v[16:19], v[4:7], v[42:45], 0
    s_add_u32 m0, s57, 16384
    s_nop 0
    buffer_load_dwordx4 v2, s[12:15], s28 offen offset:3072 lds
    s_waitcnt vmcnt(16)
    ds_read_b128 v[42:45], v48 offset:3072
    s_waitcnt lgkmcnt(2)
    v_mfma_f32_16x16x32_bf16 v[16:19], v[8:11], v[34:37], v[16:19]
    v_add_f32_dpp v32, v21, v20 quad_perm:[1,0,3,2] row_mask:0x8 bank_mask:0xf
    v_add_f32_dpp v33, v22, v23 quad_perm:[1,0,3,2] row_mask:0x8 bank_mask:0xf
    v_cndmask_b32 v29, v32, v33, s[24:25]
    v_max3_f32 v46, v46, v28, v29
    s_add_u32 s28, s27, 12288
    s_add_u32 m0, s57, -2048
    s_nop 0
    buffer_load_dwordx4 v2, s[12:15], s28 offen offset:2048 lds
    s_waitcnt vmcnt(16)
    ds_read_b128 v[34:37], v48 offset:4096
    s_waitcnt lgkmcnt(2)
    v_mfma_f32_16x16x32_bf16 v[20:23], v[4:7], v[38:41], 0
    s_add_u32 m0, s57, -2048
    s_nop 0
    buffer_load_dwordx4 v2, s[12:15], s28 offen offset:3072 lds
    s_waitcnt vmcnt(16)
    ds_read_b128 v[38:41], v48 offset:5120
    s_waitcnt lgkmcnt(2)
    v_mfma_f32_16x16x32_bf16 v[20:23], v[8:11], v[42:45], v[20:23]
    v_add_f32_dpp v32, v13, v12 quad_perm:[1,0,3,2] row_mask:0x1 bank_mask:0xf
    v_add_f32_dpp v33, v14, v15 quad_perm:[1,0,3,2] row_mask:0x1 bank_mask:0xf
    s_add_u32 s28, s27, 16384
    s_add_u32 m0, s57, 0
    s_nop 0
    buffer_load_dwordx4 v2, s[12:15], s28 offen offset:2048 lds
    s_waitcnt vmcnt(16)
    ds_read_b128 v[42:45], v48 offset:6144
    s_waitcnt lgkmcnt(2)
    v_mfma_f32_16x16x32_bf16 v[12:15], v[4:7], v[34:37], 0
    s_add_u32 m0, s57, 0
    s_nop 0
    buffer_load_dwordx4 v2, s[12:15], s28 offen offset:3072 lds
    s_waitcnt vmcnt(16)
    ds_read_b128 v[34:37], v48 offset:7168
    s_waitcnt lgkmcnt(2)
    v_mfma_f32_16x16x32_bf16 v[12:15], v[8:11], v[38:41], v[12:15]
    v_add_f32_dpp v32, v17, v16 quad_perm:[1,0,3,2] row_mask:0x2 bank_mask:0xf
    v_add_f32_dpp v33, v18, v19 quad_perm:[1,0,3,2] row_mask:0x2 bank_mask:0xf
    s_add_u32 s28, s27, 20480
    s_add_u32 m0, s57, 2048
    s_nop 0
    buffer_load_dwordx4 v2, s[12:15], s28 offen offset:2048 lds
    s_waitcnt vmcnt(16)
    ds_read_b128 v[38:41], v48 offset:8192
    s_waitcnt lgkmcnt(2)
    v_mfma_f32_16x16x32_bf16 v[16:19], v[4:7], v[42:45], 0
    s_add_u32 m0, s57, 2048
    s_nop 0
    buffer_load_dwordx4 v2, s[12:15], s28 offen offset:3072 lds
    s_waitcnt vmcnt(16)
    ds_read_b128 v[42:45], v48 offset:9216
    s_waitcnt lgkmcnt(2)
    v_mfma_f32_16x16x32_bf16 v[16:19], v[8:11], v[34:37], v[16:19]
    v_add_f32_dpp v32, v21, v20 quad_perm:[1,0,3,2] row_mask:0x4 bank_mask:0xf
    v_add_f32_dpp v33, v22, v23 quad_perm:[1,0,3,2] row_mask:0x4 bank_mask:0xf
    s_add_u32 s28, s27, 24576
    s_add_u32 m0, s57, 4096
    s_nop 0
    buffer_load_dwordx4 v2, s[12:15], s28 offen offset:2048 lds
    s_waitcnt vmcnt(16)
    ds_read_b128 v[34:37], v48 offset:10240
    s_waitcnt lgkmcnt(2)
    v_mfma_f32_16x16x32_bf16 v[20:23], v[4:7], v[38:41], 0
    s_add_u32 m0, s57, 4096
    s_nop 0
    buffer_load_dwordx4 v2, s[12:15], s28 offen offset:3072 lds
    s_waitcnt vmcnt(16)
    ds_read_b128 v[38:41], v48 offset:11264
    s_waitcnt lgkmcnt(2)
    v_mfma_f32_16x16x32_bf16 v[20:23], v[8:11], v[42:45], v[20:23]
    v_add_f32_dpp v32, v13, v12 quad_perm:[1,0,3,2] row_mask:0x8 bank_mask:0xf
    v_add_f32_dpp v33, v14, v15 quad_perm:[1,0,3,2] row_mask:0x8 bank_mask:0xf
    v_cndmask_b32 v30, v32, v33, s[24:25]
    s_add_u32 s28, s27, 28672
    s_add_u32 m0, s57, 8192
    s_nop 0
    buffer_load_dwordx4 v2, s[12:15], s28 offen offset:0 lds
    s_waitcnt vmcnt(16)
    ds_read_b128 v[42:45], v48 offset:12288
    s_waitcnt lgkmcnt(2)
    v_mfma_f32_16x16x32_bf16 v[12:15], v[4:7], v[34:37], 0
    s_add_u32 m0, s57, 8192
    s_nop 0
    buffer_load_dwordx4 v2, s[12:15], s28 offen offset:1024 lds
    s_waitcnt vmcnt(16)
    ds_read_b128 v[34:37], v48 offset:13312
    s_waitcnt lgkmcnt(2)
    v_mfma_f32_16x16x32_bf16 v[12:15], v[8:11], v[38:41], v[12:15]
    v_add_f32_dpp v32, v17, v16 quad_perm:[1,0,3,2] row_mask:0x1 bank_mask:0xf
    v_add_f32_dpp v33, v18, v19 quad_perm:[1,0,3,2] row_mask:0x1 bank_mask:0xf
    s_waitcnt lgkmcnt(1)
    v_mfma_f32_16x16x32_bf16 v[16:19], v[4:7], v[42:45], 0
    s_waitcnt lgkmcnt(0)
    v_mfma_f32_16x16x32_bf16 v[16:19], v[8:11], v[34:37], v[16:19]
    v_add_f32_dpp v32, v21, v20 quad_perm:[1,0,3,2] row_mask:0x2 bank_mask:0xf
    v_add_f32_dpp v33, v22, v23 quad_perm:[1,0,3,2] row_mask:0x2 bank_mask:0xf
    v_add_f32_dpp v32, v13, v12 quad_perm:[1,0,3,2] row_mask:0x4 bank_mask:0xf
    v_add_f32_dpp v33, v14, v15 quad_perm:[1,0,3,2] row_mask:0x4 bank_mask:0xf
    s_nop 3
    v_add_f32_dpp v32, v17, v16 quad_perm:[1,0,3,2] row_mask:0x8 bank_mask:0xf
    v_add_f32_dpp v33, v18, v19 quad_perm:[1,0,3,2] row_mask:0x8 bank_mask:0xf
    v_cndmask_b32 v31, v32, v33, s[24:25]
    v_max3_f32 v46, v46, v30, v31
    s_nop 1
    v_max_f32_dpp v46, v46, v46 quad_perm:[2,3,0,1] row_mask:0xf bank_mask:0xf
    s_nop 1
    v_max_f32_dpp v46, v46, v46 row_ror:4 row_mask:0xf bank_mask:0xf
    s_nop 1
    v_max_f32_dpp v46, v46, v46 row_ror:8 row_mask:0xf bank_mask:0xf
    v_mov_b32 v32, v46
    s_nop 1
    v_permlane16_swap_b32 v46, v32
    v_max_f32 v46, v46, v32
    v_mov_b32 v32, v46
    s_nop 1
    v_permlane32_swap_b32 v46, v32
    v_max_f32 v46, v46, v32
    v_mul_f32 v32, s26, v46
    v_fma_f32 v24, v24, s26, -v32
    v_fma_f32 v25, v25, s26, -v32
    v_fma_f32 v26, v26, s26, -v32
    v_fma_f32 v27, v27, s26, -v32
    v_fma_f32 v28, v28, s26, -v32
    v_fma_f32 v29, v29, s26, -v32
    v_fma_f32 v30, v30, s26, -v32
    v_fma_f32 v31, v31, s26, -v32
    v_exp_f32 v24, v24
    v_exp_f32 v25, v25
    v_exp_f32 v26, v26
    v_exp_f32 v27, v27
    v_exp_f32 v28, v28
    v_exp_f32 v29, v29
    v_exp_f32 v30, v30
    v_exp_f32 v31, v31
    v_pk_add_f32 v[4:5], v[24:25], v[26:27]
    v_pk_add_f32 v[6:7], v[28:29], v[30:31]
    v_pk_add_f32 v[4:5], v[4:5], v[6:7]
    v_add_f32 v20, v4, v5
    v_mov_b32_dpp v21, v24 quad_perm:[1,0,3,2] row_mask:0xf bank_mask:0xf
    v_cvt_pk_bf16_f32 v24, v24, v21
    v_mov_b32_dpp v22, v25 quad_perm:[1,0,3,2] row_mask:0xf bank_mask:0xf
    v_add_f32_dpp v20, v20, v20 quad_perm:[2,3,0,1] row_mask:0xf bank_mask:0xf
    v_cvt_pk_bf16_f32 v25, v25, v22
    v_mov_b32_dpp v21, v26 quad_perm:[1,0,3,2] row_mask:0xf bank_mask:0xf
    v_cvt_pk_bf16_f32 v26, v26, v21
    v_mov_b32_dpp v22, v27 quad_perm:[1,0,3,2] row_mask:0xf bank_mask:0xf
    v_add_f32_dpp v20, v20, v20 row_ror:8 row_mask:0xf bank_mask:0xf
    v_cvt_pk_bf16_f32 v27, v27, v22
    v_mov_b32_dpp v21, v28 quad_perm:[1,0,3,2] row_mask:0xf bank_mask:0xf
    v_cvt_pk_bf16_f32 v28, v28, v21
    v_mov_b32_dpp v22, v29 quad_perm:[1,0,3,2] row_mask:0xf bank_mask:0xf
    v_add_f32_dpp v20, v20, v20 row_ror:4 row_mask:0xf bank_mask:0xf
    v_cvt_pk_bf16_f32 v29, v29, v22
    v_mov_b32_dpp v21, v30 quad_perm:[1,0,3,2] row_mask:0xf bank_mask:0xf
    v_cvt_pk_bf16_f32 v30, v30, v21
    v_mov_b32_dpp v22, v31 quad_perm:[1,0,3,2] row_mask:0xf bank_mask:0xf
    v_cvt_pk_bf16_f32 v31, v31, v22
    v_mov_b32 v21, v20
    s_nop 1
    v_permlane16_swap_b32 v20, v21
    v_add_f32 v20, v20, v21
    v_mov_b32 v21, v20
    s_nop 1
    v_permlane32_swap_b32 v20, v21
    v_add_f32 v20, v20, v21
    v_and_b32 v32, 3, v0
    v_mul_u32_u24 v32, 0x5555, v32
    v_mov_b32 v34, 0
    v_mov_b32 v35, 0
    v_mov_b32 v36, 0
    v_mov_b32 v37, 0
    v_mov_b32 v38, 0
    v_mov_b32 v39, 0
    v_mov_b32 v40, 0
    v_mov_b32 v41, 0
    v_mov_b32 v42, 0
    v_mov_b32 v43, 0
    v_mov_b32 v44, 0
    v_mov_b32 v45, 0
    v_add_u32 v33, s57, v2
    s_add_u32 m0, s57, 8192
    s_nop 0
    buffer_load_dwordx4 v2, s[12:15], s28 offen offset:2048 lds
    s_waitcnt vmcnt(16)
    ds_read_b128 v[4:7], v33 offset:14336
    s_add_u32 m0, s57, 8192
    s_nop 0
    buffer_load_dwordx4 v2, s[12:15], s28 offen offset:3072 lds
    s_waitcnt vmcnt(16)
    ds_read_b128 v[8:11], v33 offset:15360
    v_and_b32_dpp v34, v24, v3 row_newbcast:4 row_mask:0xf bank_mask:0x3
    v_and_b32_dpp v35, v24, v3 row_newbcast:4 row_mask:0xf bank_mask:0xc
    v_and_b32_dpp v36, v24, v3 row_newbcast:6 row_mask:0xf bank_mask:0x3
    v_and_b32_dpp v37, v24, v3 row_newbcast:6 row_mask:0xf bank_mask:0xc
    s_add_u32 s28, s27, 32768
    s_add_u32 m0, s57, 12288
    s_nop 0
    buffer_load_dwordx4 v2, s[12:15], s28 offen offset:0 lds
    s_waitcnt vmcnt(16)
    ds_read_b128 v[12:15], v33 offset:16384
    s_add_u32 m0, s57, 12288
    s_nop 0
    buffer_load_dwordx4 v2, s[12:15], s28 offen offset:1024 lds
    s_waitcnt vmcnt(16)
    ds_read_b128 v[16:19], v33 offset:17408
    s_waitcnt lgkmcnt(2)
    v_smfmac_f32_16x16x64_bf16 v[42:45], v[34:37], v[4:11], v32
    v_and_b32_dpp v38, v24, v3 row_newbcast:12 row_mask:0xf bank_mask:0x3
    v_and_b32_dpp v39, v24, v3 row_newbcast:12 row_mask:0xf bank_mask:0xc
    v_and_b32_dpp v40, v24, v3 row_newbcast:14 row_mask:0xf bank_mask:0x3
    v_and_b32_dpp v41, v24, v3 row_newbcast:14 row_mask:0xf bank_mask:0xc
    s_add_u32 m0, s57, 12288
    s_nop 0
    buffer_load_dwordx4 v2, s[12:15], s28 offen offset:2048 lds
    s_waitcnt vmcnt(16)
    ds_read_b128 v[4:7], v33 offset:18432
    s_add_u32 m0, s57, 12288
    s_nop 0
    buffer_load_dwordx4 v2, s[12:15], s28 offen offset:3072 lds
    s_waitcnt vmcnt(16)
    ds_read_b128 v[8:11], v33 offset:19456
    s_waitcnt lgkmcnt(2)
    v_smfmac_f32_16x16x64_bf16 v[42:45], v[38:41], v[12:19], v32
    v_and_b32_dpp v34, v25, v3 row_newbcast:4 row_mask:0xf bank_mask:0x3
    v_and_b32_dpp v35, v25, v3 row_newbcast:4 row_mask:0xf bank_mask:0xc
    v_and_b32_dpp v36, v25, v3 row_newbcast:6 row_mask:0xf bank_mask:0x3
    v_and_b32_dpp v37, v25, v3 row_newbcast:6 row_mask:0xf bank_mask:0xc
    s_add_u32 s28, s27, 36864
    s_add_u32 m0, s57, 16384
    s_nop 0
    buffer_load_dwordx4 v2, s[12:15], s28 offen offset:0 lds
    s_waitcnt vmcnt(16)
    ds_read_b128 v[12:15], v33 offset:0
    s_add_u32 m0, s57, 16384
    s_nop 0
    buffer_load_dwordx4 v2, s[12:15], s28 offen offset:1024 lds
    s_waitcnt vmcnt(16)
    ds_read_b128 v[16:19], v33 offset:1024
    s_waitcnt lgkmcnt(2)
    v_smfmac_f32_16x16x64_bf16 v[42:45], v[34:37], v[4:11], v32
    v_and_b32_dpp v38, v25, v3 row_newbcast:12 row_mask:0xf bank_mask:0x3
    v_and_b32_dpp v39, v25, v3 row_newbcast:12 row_mask:0xf bank_mask:0xc
    v_and_b32_dpp v40, v25, v3 row_newbcast:14 row_mask:0xf bank_mask:0x3
    v_and_b32_dpp v41, v25, v3 row_newbcast:14 row_mask:0xf bank_mask:0xc
    s_add_u32 m0, s57, 16384
    s_nop 0
    buffer_load_dwordx4 v2, s[12:15], s28 offen offset:2048 lds
    s_waitcnt vmcnt(16)
    ds_read_b128 v[4:7], v33 offset:2048
    s_add_u32 m0, s57, 16384
    s_nop 0
    buffer_load_dwordx4 v2, s[12:15], s28 offen offset:3072 lds
    s_waitcnt vmcnt(16)
    ds_read_b128 v[8:11], v33 offset:3072
    s_waitcnt lgkmcnt(2)
    v_smfmac_f32_16x16x64_bf16 v[42:45], v[38:41], v[12:19], v32
    v_and_b32_dpp v34, v26, v3 row_newbcast:4 row_mask:0xf bank_mask:0x3
    v_and_b32_dpp v35, v26, v3 row_newbcast:4 row_mask:0xf bank_mask:0xc
    v_and_b32_dpp v36, v26, v3 row_newbcast:6 row_mask:0xf bank_mask:0x3
    v_and_b32_dpp v37, v26, v3 row_newbcast:6 row_mask:0xf bank_mask:0xc
    s_add_u32 s28, s27, 0
    s_add_u32 m0, s57, 0
    s_nop 0
    buffer_load_dwordx4 v2, s[12:15], s28 offen offset:0 lds
    s_waitcnt vmcnt(16)
    ds_read_b128 v[12:15], v33 offset:4096
    s_add_u32 m0, s57, 0
    s_nop 0
    buffer_load_dwordx4 v2, s[12:15], s28 offen offset:1024 lds
    s_waitcnt vmcnt(16)
    ds_read_b128 v[16:19], v33 offset:5120
    s_waitcnt lgkmcnt(2)
    v_smfmac_f32_16x16x64_bf16 v[42:45], v[34:37], v[4:11], v32
    v_and_b32_dpp v38, v26, v3 row_newbcast:12 row_mask:0xf bank_mask:0x3
    v_and_b32_dpp v39, v26, v3 row_newbcast:12 row_mask:0xf bank_mask:0xc
    v_and_b32_dpp v40, v26, v3 row_newbcast:14 row_mask:0xf bank_mask:0x3
    v_and_b32_dpp v41, v26, v3 row_newbcast:14 row_mask:0xf bank_mask:0xc
    s_add_u32 s28, s27, 4096
    s_add_u32 m0, s57, 2048
    s_nop 0
    buffer_load_dwordx4 v2, s[12:15], s28 offen offset:0 lds
    s_waitcnt vmcnt(16)
    ds_read_b128 v[4:7], v33 offset:6144
    s_add_u32 m0, s57, 2048
    s_nop 0
    buffer_load_dwordx4 v2, s[12:15], s28 offen offset:1024 lds
    s_waitcnt vmcnt(16)
    ds_read_b128 v[8:11], v33 offset:7168
    s_waitcnt lgkmcnt(2)
    v_smfmac_f32_16x16x64_bf16 v[42:45], v[38:41], v[12:19], v32
    v_and_b32_dpp v34, v27, v3 row_newbcast:4 row_mask:0xf bank_mask:0x3
    v_and_b32_dpp v35, v27, v3 row_newbcast:4 row_mask:0xf bank_mask:0xc
    v_and_b32_dpp v36, v27, v3 row_newbcast:6 row_mask:0xf bank_mask:0x3
    v_and_b32_dpp v37, v27, v3 row_newbcast:6 row_mask:0xf bank_mask:0xc
    s_add_u32 s28, s27, 8192
    s_add_u32 m0, s57, 4096
    s_nop 0
    buffer_load_dwordx4 v2, s[12:15], s28 offen offset:0 lds
    s_waitcnt vmcnt(16)
    ds_read_b128 v[12:15], v33 offset:8192
    s_add_u32 m0, s57, 4096
    s_nop 0
    buffer_load_dwordx4 v2, s[12:15], s28 offen offset:1024 lds
    s_waitcnt vmcnt(16)
    ds_read_b128 v[16:19], v33 offset:9216
    s_waitcnt lgkmcnt(2)
    v_smfmac_f32_16x16x64_bf16 v[42:45], v[34:37], v[4:11], v32
    v_and_b32_dpp v38, v27, v3 row_newbcast:8 row_mask:0xf bank_mask:0x3
    v_and_b32_dpp v39, v27, v3 row_newbcast:8 row_mask:0xf bank_mask:0xc
    v_and_b32_dpp v40, v27, v3 row_newbcast:10 row_mask:0xf bank_mask:0x3
    v_and_b32_dpp v41, v27, v3 row_newbcast:10 row_mask:0xf bank_mask:0xc
    s_add_u32 s28, s27, 12288
    s_add_u32 m0, s57, 6144
    s_nop 0
    buffer_load_dwordx4 v2, s[12:15], s28 offen offset:0 lds
    s_waitcnt vmcnt(16)
    ds_read_b128 v[4:7], v33 offset:10240
    s_add_u32 m0, s57, 6144
    s_nop 0
    buffer_load_dwordx4 v2, s[12:15], s28 offen offset:1024 lds
    s_waitcnt vmcnt(16)
    ds_read_b128 v[8:11], v33 offset:11264
    s_waitcnt lgkmcnt(2)
    v_smfmac_f32_16x16x64_bf16 v[42:45], v[38:41], v[12:19], v32
    v_and_b32_dpp v34, v27, v3 row_newbcast:12 row_mask:0xf bank_mask:0x3
    v_and_b32_dpp v35, v27, v3 row_newbcast:12 row_mask:0xf bank_mask:0xc
    v_and_b32_dpp v36, v27, v3 row_newbcast:14 row_mask:0xf bank_mask:0x3
    v_and_b32_dpp v37, v27, v3 row_newbcast:14 row_mask:0xf bank_mask:0xc
    s_add_u32 s28, s27, 16384
    s_add_u32 m0, s57, 8192
    s_nop 0
    buffer_load_dwordx4 v2, s[12:15], s28 offen offset:0 lds
    s_waitcnt vmcnt(16)
    ds_read_b128 v[12:15], v33 offset:12288
    s_add_u32 m0, s57, 8192
    s_nop 0
    buffer_load_dwordx4 v2, s[12:15], s28 offen offset:1024 lds
    s_waitcnt vmcnt(16)
    ds_read_b128 v[16:19], v33 offset:13312
    s_waitcnt lgkmcnt(2)
    v_smfmac_f32_16x16x64_bf16 v[42:45], v[34:37], v[4:11], v32
    v_and_b32_dpp v38, v28, v3 row_newbcast:0 row_mask:0xf bank_mask:0x3
    v_and_b32_dpp v39, v28, v3 row_newbcast:0 row_mask:0xf bank_mask:0xc
    v_and_b32_dpp v40, v28, v3 row_newbcast:2 row_mask:0xf bank_mask:0x3
    v_and_b32_dpp v41, v28, v3 row_newbcast:2 row_mask:0xf bank_mask:0xc
    s_add_u32 s28, s27, 20480
    s_add_u32 m0, s57, 10240
    s_nop 0
    buffer_load_dwordx4 v2, s[12:15], s28 offen offset:0 lds
    s_waitcnt vmcnt(16)
    ds_read_b128 v[4:7], v33 offset:14336
    s_add_u32 m0, s57, 10240
    s_nop 0
    buffer_load_dwordx4 v2, s[12:15], s28 offen offset:1024 lds
    s_waitcnt vmcnt(16)
    ds_read_b128 v[8:11], v33 offset:15360
    s_waitcnt lgkmcnt(2)
    v_smfmac_f32_16x16x64_bf16 v[42:45], v[38:41], v[12:19], v32
    v_and_b32_dpp v34, v28, v3 row_newbcast:4 row_mask:0xf bank_mask:0x3
    v_and_b32_dpp v35, v28, v3 row_newbcast:4 row_mask:0xf bank_mask:0xc
    v_and_b32_dpp v36, v28, v3 row_newbcast:6 row_mask:0xf bank_mask:0x3
    v_and_b32_dpp v37, v28, v3 row_newbcast:6 row_mask:0xf bank_mask:0xc
    s_add_u32 s28, s27, 24576
    s_add_u32 m0, s57, 12288
    s_nop 0
    buffer_load_dwordx4 v2, s[12:15], s28 offen offset:0 lds
    s_waitcnt vmcnt(16)
    ds_read_b128 v[12:15], v33 offset:16384
    s_add_u32 m0, s57, 12288
    s_nop 0
    buffer_load_dwordx4 v2, s[12:15], s28 offen offset:1024 lds
    s_waitcnt vmcnt(16)
    ds_read_b128 v[16:19], v33 offset:17408
    s_waitcnt lgkmcnt(2)
    v_smfmac_f32_16x16x64_bf16 v[42:45], v[34:37], v[4:11], v32
    v_and_b32_dpp v38, v28, v3 row_newbcast:8 row_mask:0xf bank_mask:0x3
    v_and_b32_dpp v39, v28, v3 row_newbcast:8 row_mask:0xf bank_mask:0xc
    v_and_b32_dpp v40, v28, v3 row_newbcast:10 row_mask:0xf bank_mask:0x3
    v_and_b32_dpp v41, v28, v3 row_newbcast:10 row_mask:0xf bank_mask:0xc
    s_waitcnt vmcnt(15)
    ds_read_b128 v[4:7], v33 offset:18432
    s_waitcnt vmcnt(14)
    ds_read_b128 v[8:11], v33 offset:19456
    s_waitcnt lgkmcnt(2)
    v_smfmac_f32_16x16x64_bf16 v[42:45], v[38:41], v[12:19], v32
    v_and_b32_dpp v34, v28, v3 row_newbcast:12 row_mask:0xf bank_mask:0x3
    v_and_b32_dpp v35, v28, v3 row_newbcast:12 row_mask:0xf bank_mask:0xc
    v_and_b32_dpp v36, v28, v3 row_newbcast:14 row_mask:0xf bank_mask:0x3
    v_and_b32_dpp v37, v28, v3 row_newbcast:14 row_mask:0xf bank_mask:0xc
    s_waitcnt vmcnt(13)
    ds_read_b128 v[12:15], v33 offset:0
    s_waitcnt vmcnt(12)
    ds_read_b128 v[16:19], v33 offset:1024
    s_waitcnt lgkmcnt(2)
    v_smfmac_f32_16x16x64_bf16 v[42:45], v[34:37], v[4:11], v32
    v_and_b32_dpp v38, v24, v3 row_newbcast:0 row_mask:0xf bank_mask:0x3
    v_and_b32_dpp v39, v24, v3 row_newbcast:0 row_mask:0xf bank_mask:0xc
    v_and_b32_dpp v40, v24, v3 row_newbcast:2 row_mask:0xf bank_mask:0x3
    v_and_b32_dpp v41, v24, v3 row_newbcast:2 row_mask:0xf bank_mask:0xc
    s_waitcnt vmcnt(11)
    ds_read_b128 v[4:7], v33 offset:2048
    s_waitcnt vmcnt(10)
    ds_read_b128 v[8:11], v33 offset:3072
    s_waitcnt lgkmcnt(2)
    v_smfmac_f32_16x16x64_bf16 v[42:45], v[38:41], v[12:19], v32
    v_and_b32_dpp v34, v24, v3 row_newbcast:8 row_mask:0xf bank_mask:0x3
    v_and_b32_dpp v35, v24, v3 row_newbcast:8 row_mask:0xf bank_mask:0xc
    v_and_b32_dpp v36, v24, v3 row_newbcast:10 row_mask:0xf bank_mask:0x3
    v_and_b32_dpp v37, v24, v3 row_newbcast:10 row_mask:0xf bank_mask:0xc
    s_waitcnt vmcnt(9)
    ds_read_b128 v[12:15], v33 offset:4096
    s_waitcnt vmcnt(8)
    ds_read_b128 v[16:19], v33 offset:5120
    s_waitcnt lgkmcnt(2)
    v_smfmac_f32_16x16x64_bf16 v[42:45], v[34:37], v[4:11], v32
    v_and_b32_dpp v38, v25, v3 row_newbcast:0 row_mask:0xf bank_mask:0x3
    v_and_b32_dpp v39, v25, v3 row_newbcast:0 row_mask:0xf bank_mask:0xc
    v_and_b32_dpp v40, v25, v3 row_newbcast:2 row_mask:0xf bank_mask:0x3
    v_and_b32_dpp v41, v25, v3 row_newbcast:2 row_mask:0xf bank_mask:0xc
    s_waitcnt vmcnt(7)
    ds_read_b128 v[4:7], v33 offset:6144
    s_waitcnt vmcnt(6)
    ds_read_b128 v[8:11], v33 offset:7168
    s_waitcnt lgkmcnt(2)
    v_smfmac_f32_16x16x64_bf16 v[42:45], v[38:41], v[12:19], v32
    v_and_b32_dpp v34, v25, v3 row_newbcast:8 row_mask:0xf bank_mask:0x3
    v_and_b32_dpp v35, v25, v3 row_newbcast:8 row_mask:0xf bank_mask:0xc
    v_and_b32_dpp v36, v25, v3 row_newbcast:10 row_mask:0xf bank_mask:0x3
    v_and_b32_dpp v37, v25, v3 row_newbcast:10 row_mask:0xf bank_mask:0xc
    s_waitcnt vmcnt(5)
    ds_read_b128 v[12:15], v33 offset:8192
    s_waitcnt vmcnt(4)
    ds_read_b128 v[16:19], v33 offset:9216
    s_waitcnt lgkmcnt(2)
    v_smfmac_f32_16x16x64_bf16 v[42:45], v[34:37], v[4:11], v32
    v_and_b32_dpp v38, v26, v3 row_newbcast:0 row_mask:0xf bank_mask:0x3
    v_and_b32_dpp v39, v26, v3 row_newbcast:0 row_mask:0xf bank_mask:0xc
    v_and_b32_dpp v40, v26, v3 row_newbcast:2 row_mask:0xf bank_mask:0x3
    v_and_b32_dpp v41, v26, v3 row_newbcast:2 row_mask:0xf bank_mask:0xc
    s_waitcnt vmcnt(3)
    ds_read_b128 v[4:7], v33 offset:10240
    s_waitcnt vmcnt(2)
    ds_read_b128 v[8:11], v33 offset:11264
    s_waitcnt lgkmcnt(2)
    v_smfmac_f32_16x16x64_bf16 v[42:45], v[38:41], v[12:19], v32
    v_and_b32_dpp v34, v26, v3 row_newbcast:8 row_mask:0xf bank_mask:0x3
    v_and_b32_dpp v35, v26, v3 row_newbcast:8 row_mask:0xf bank_mask:0xc
    v_and_b32_dpp v36, v26, v3 row_newbcast:10 row_mask:0xf bank_mask:0x3
    v_and_b32_dpp v37, v26, v3 row_newbcast:10 row_mask:0xf bank_mask:0xc
    s_waitcnt vmcnt(1)
    ds_read_b128 v[12:15], v33 offset:12288
    s_waitcnt vmcnt(0)
    ds_read_b128 v[16:19], v33 offset:13312
    s_waitcnt lgkmcnt(2)
    v_smfmac_f32_16x16x64_bf16 v[42:45], v[34:37], v[4:11], v32
    v_and_b32_dpp v38, v27, v3 row_newbcast:0 row_mask:0xf bank_mask:0x3
    v_and_b32_dpp v39, v27, v3 row_newbcast:0 row_mask:0xf bank_mask:0xc
    v_and_b32_dpp v40, v27, v3 row_newbcast:2 row_mask:0xf bank_mask:0x3
    v_and_b32_dpp v41, v27, v3 row_newbcast:2 row_mask:0xf bank_mask:0xc
    s_waitcnt lgkmcnt(0)
    s_nop 0
    v_smfmac_f32_16x16x64_bf16 v[42:45], v[38:41], v[12:19], v32
    v_mov_b32 v47, v20
    ds_write_b128 v33, v[24:27] offset:14336
    ds_write_b128 v33, v[28:31] offset:15360
    ds_write_b64 v33, v[46:47] offset:17408
    s_nop 3
    ds_write_b128 v33, v[42:45] offset:16384
    s_waitcnt lgkmcnt(0)
    s_setpc_b64 s[30:31]
SUB_RESUME:
    s_mov_b32 s82, 13
    s_call_b64 s[80:81], SUB_LN
    s_call_b64 s[80:81], SUB_LN
    v_bfe_u32 v15, v0, 1, 1
    v_lshlrev_b32 v12, 8, v15
    v_lshrrev_b32 v13, 4, v0
    v_lshl_add_u32 v12, v13, 5, v12
    v_and_b32 v14, 1, v0
    v_lshl_add_u32 v12, v14, 4, v12
    v_add_u32 v12, s65, v12
    v_bfe_u32 v15, v0, 4, 1
    v_lshlrev_b32 v47, 9, v15
    v_and_b32 v15, 15, v0
    v_lshl_add_u32 v47, v15, 5, v47
    v_lshrrev_b32 v15, 5, v0
    v_lshl_add_u32 v47, v15, 4, v47
    s_lshl_b32 s70, s3, 10
    s_add_u32 s70, s70, s64
    v_add_u32 v47, s70, v47
    v_mov_b32 v34, 0
    v_mov_b32 v35, 0
    v_mov_b32 v36, 0
    v_mov_b32 v37, 0
    v_mov_b32 v38, 0
    v_mov_b32 v39, 0
    v_mov_b32 v40, 0
    v_mov_b32 v41, 0
    v_mov_b32 v42, 0
    v_mov_b32 v43, 0
    v_mov_b32 v44, 0
    v_mov_b32 v45, 0
    v_add_u32 v33, s57, v2
    ds_read_b128 v[24:27], v33 offset:14336
    ds_read_b128 v[28:31], v33 offset:15360
    ds_read_b128 v[42:45], v33 offset:16384
    ds_read_b64 v[22:23], v33 offset:17408
    v_and_b32 v32, 3, v0
    v_mul_u32_u24 v32, 0x5555, v32
    s_mov_b64 vcc, -1
    s_waitcnt lgkmcnt(0)
    v_mov_b32 v46, v22
    v_mov_b32 v20, v23
    v_and_b32_dpp v34, v29, v3 row_newbcast:0 row_mask:0xf bank_mask:0x3
    v_and_b32_dpp v35, v29, v3 row_newbcast:0 row_mask:0xf bank_mask:0xc
    v_and_b32_dpp v36, v29, v3 row_newbcast:2 row_mask:0xf bank_mask:0x3
    v_and_b32_dpp v37, v29, v3 row_newbcast:2 row_mask:0xf bank_mask:0xc
    s_nop 1
    s_branch L_att_resume
Lt_1:
    s_call_b64 s[34:35], SUB_LNW
    s_branch Ltb_2
Lt_3:
    s_call_b64 s[34:35], SUB_LNW
    s_branch Ltb_4
Lt_5:
    s_call_b64 s[80:81], SUB_LN
    s_branch Ltb_6
Lt_10:
    s_call_b64 s[34:35], SUB_LNW
    s_branch Ltb_11
Lt_15:
    s_call_b64 s[34:35], SUB_LNW
    s_branch Ltb_16
Lt_30:
    s_call_b64 s[34:35], SUB_LNW
    s_branch Ltb_31
Lt_51:
    s_call_b64 s[34:35], SUB_LNW
    s_branch Ltb_52
Lt_70:
    s_call_b64 s[34:35], SUB_LNW
    s_branch Ltb_71
Lt_72:
    s_call_b64 s[80:81], SUB_LN
    s_branch Ltb_73
Lt_77:
    s_call_b64 s[34:35], SUB_LNW
    s_branch Ltb_78
Lt_79:
    s_call_b64 s[80:81], SUB_LN
    s_branch Ltb_80
Lt_84:
    s_call_b64 s[34:35], SUB_LNW
    s_branch Ltb_85
Lgs_65:
    s_nop 7
    buffer_store_dwordx4 v[4:7], v2, s[16:19], s70 offen sc1
    s_mov_b32 exec_lo, 1
    s_mov_b32 exec_hi, 1
    buffer_store_dword v29, v34, s[16:19], s71 offen sc1
    s_mov_b64 exec, -1
    s_branch Lgb_66
Lgs_86:
    s_nop 7
    s_mov_b64 exec, 1
    buffer_store_dword v19, v19, s[16:19], s73 offen sc1
    s_mov_b64 exec, -1
    s_branch Lgb_87
Lgs_88:
    s_nop 7
    buffer_store_dword v12, v19, s[16:19], s74 offen sc1
    s_branch Lgb_89
Lpr_9:
    s_sleep 2
    s_add_u32 s68, s68, 1
    s_cmp_lt_u32 s68, 400000
    s_cbranch_scc1 Lpoll_7
    s_branch Lpd_8
Lpr_14:
    s_sleep 2
    s_add_u32 s68, s68, 1
    s_cmp_lt_u32 s68, 400000
    s_cbranch_scc1 Lpoll_12
    s_branch Lpd_13
Lpr_29:
    s_sleep 2
    s_add_u32 s68, s68, 1
    s_cmp_lt_u32 s68, 400000
    s_cbranch_scc1 Lpoll_27
    s_branch Lpd_28
Lpr_50:
    s_sleep 2
    s_add_u32 s68, s68, 1
    s_cmp_lt_u32 s68, 400000
    s_cbranch_scc1 Lpoll_48
    s_branch Lpd_49
Lpr_69:
    s_sleep 2
    s_add_u32 s68, s68, 1
    s_cmp_lt_u32 s68, 400000
    s_cbranch_scc1 Lpoll_67
    s_branch Lpd_68
Lpr_76:
    s_sleep 2
    s_add_u32 s68, s68, 1
    s_cmp_lt_u32 s68, 400000
    s_cbranch_scc1 Lpoll_74
    s_branch Lpd_75
Lpr_83:
    s_sleep 2
    s_add_u32 s68, s68, 1
    s_cmp_lt_u32 s68, 400000
    s_cbranch_scc1 Lpoll_81
    s_branch Lpd_82
L_code_end:
.section .rodata,"a"
.p2align 6
.amdhsa_kernel interleave_layers__gqa_block_cached__mixer_token_mlp__decode_kernel
  .amdhsa_next_free_vgpr 512
  .amdhsa_next_free_sgpr 102
  .amdhsa_accum_offset 256
  .amdhsa_group_segment_fixed_size 0
  .amdhsa_kernarg_size 104
  .amdhsa_user_sgpr_count 2
  .amdhsa_user_sgpr_kernarg_segment_ptr 1
  .amdhsa_system_sgpr_workgroup_id_x 1
.end_amdhsa_kernel
```
